```python
import torch

def _softmax(x, axis=-1):
    return torch.softmax(x, dim=axis)
def _gelu(x):
    return torch.nn.functional.gelu(x, approximate="tanh")
def _silu(x):
    return torch.nn.functional.silu(x)
def _sigmoid(x):
    return torch.sigmoid(x)
def _layernorm(x, axis=-1, eps=1e-5):
    m = x.mean(dim=axis, keepdim=True)
    v = x.var(dim=axis, keepdim=True, unbiased=False)
    return (x - m) / torch.sqrt(v + eps)
def _scatter_add(tgt, idx, src, axis=0):
    return tgt.clone().index_add_(axis, idx, src)
def _segment_sum(src, seg, n):
    out = torch.zeros((n,) + src.shape[1:], dtype=src.dtype)
    return out.index_add_(0, seg, src)
def _pad(x, pw):
    flat = tuple(v for pair in reversed(pw) for v in pair)
    return torch.nn.functional.pad(x, flat)

kernel_name = 'sequential_preLN__mha_block__moe_arch_mod__prompt'

def setup_inputs():

    _w = (lambda a: (lambda t: t.to(torch.bfloat16) if t.is_floating_point() else t)(torch.as_tensor(a)))
    def _A_setup():
        B, S, D, H = 1, 2048, 448, 16
        return {
            "x": _w((lambda *s: torch.randn(*s, dtype=torch.bfloat16) * 0.05)(B, S, D)),
            "wqkv": _w((lambda *s: torch.randn(*s, dtype=torch.bfloat16) * 0.05)(D, 3 * D)),
            "wo": _w((lambda *s: torch.randn(*s, dtype=torch.bfloat16) * 0.05)(D, D)),
        }
    _A_in = _A_setup()

    def _B_setup():
        B, S, D, F, C = 1, 2048, 448, 1792, 2
        return {
            "x": _w((lambda *s: torch.randn(*s, dtype=torch.bfloat16) * 0.05)(B, S, D)),
            "w_r": _w((lambda *s: torch.randn(*s, dtype=torch.bfloat16) * 0.05)(D)),
            "w_gate": _w((lambda *s: torch.randn(*s, dtype=torch.bfloat16) * 0.05)(D, F)),
            "w_up": _w((lambda *s: torch.randn(*s, dtype=torch.bfloat16) * 0.05)(D, F)),
            "w_down": _w((lambda *s: torch.randn(*s, dtype=torch.bfloat16) * 0.05)(F, D)),
        }
    _B_in = _B_setup()

    return {
        "A_x": _A_in["x"],
        "A_wqkv": _A_in["wqkv"],
        "A_wo": _A_in["wo"],
        "B_x": _B_in["x"],
        "B_w_r": _B_in["w_r"],
        "B_w_gate": _B_in["w_gate"],
        "B_w_up": _B_in["w_up"],
        "B_w_down": _B_in["w_down"],
    }

def reference(A_x, A_wqkv, A_wo, B_x, B_w_r, B_w_gate, B_w_up, B_w_down):
    def _A_ref(x, wqkv, wo):
        B, S, D = x.shape
        H = 16
        Dh = D // H
        qkv = (lambda x, *d: x.permute(*d))((x @ wqkv).reshape(B, S, 3, H, Dh), 2, 0, 3, 1, 4)
        q, k, v = qkv[0], qkv[1], qkv[2]
        scores = torch.einsum("bhqd,bhkd->bhqk", q, k) * (Dh ** -0.5)
        p = _softmax(scores, axis=-1)
        o = torch.einsum("bhqk,bhkd->bhqd", p, v)
        return (lambda x, *d: x.permute(*d))(o, 0, 2, 1, 3).reshape(B, S, D) @ wo

    def _B_ref(x, w_r, w_gate, w_up, w_down):
        B, S, D = x.shape
        C = 2
        r = x @ w_r
        idx = torch.argsort(-r, axis=-1)[:, :C]
        idx_e = (lambda x, n, axis: torch.repeat_interleave(x, n, dim=axis))(idx.reshape(B, C, 1), D, axis=2)
        x_sel = (lambda x, i, axis: torch.take_along_dim(x, i, dim=axis))(x, idx_e, axis=1)
        g = _silu(x_sel @ w_gate)
        u = x_sel @ w_up
        y = (g * u) @ w_down
        r_sel = _sigmoid((lambda x, i, axis: torch.take_along_dim(x, i, dim=axis))(r, idx, axis=1))
        y = y * r_sel.reshape(B, C, 1)
        b_off = (torch.arange(B) * S).reshape(B, 1)
        flat_idx = (idx + b_off).reshape(B * C)
        zero = (x * 0.0).reshape(B * S, D)
        upd = _scatter_add(zero, flat_idx, y.reshape(B * C, D), axis=0)
        return x + upd.reshape(B, S, D)

    x = A_x
    h = x + _A_ref(_layernorm(x, axis=-1), A_wqkv, A_wo)
    h2 = h + _B_ref(_layernorm(h, axis=-1), B_w_r, B_w_gate, B_w_up, B_w_down)
    return h2
```

```asm
; @launch grid=(256,1,1) block=(512,1,1) lds=163840
.amdgcn_target "amdgcn-amd-amdhsa--gfx950"
.text
.p2align 12
.fill 832, 4, 0xbf810000
.globl sequential_preLN__mha_block__moe_arch_mod__prompt_kernel
.p2align 8
.type sequential_preLN__mha_block__moe_arch_mod__prompt_kernel,@function
sequential_preLN__mha_block__moe_arch_mod__prompt_kernel:
    s_cmp_ge_u32 s2, 256
    s_cbranch_scc1 Lexit
    s_load_dwordx16 s[64:79], s[0:1], 0
    s_load_dwordx2 s[80:81], s[0:1], 64
    s_load_dwordx2 s[84:85], s[0:1], 80
    v_lshrrev_b32 v1, 6, v0
    v_and_b32 v2, 63, v0
    v_readfirstlane_b32 s28, v1
    s_and_b32 s52, s2, 7
    s_lshr_b32 s51, s2, 3
    s_and_b32 s31, s51, 15
    s_lshr_b32 s35, s51, 4
    s_lshl_b32 s36, s52, 1
    s_add_u32 s32, s36, s35
    s_lshl_b32 s36, s35, 3
    s_add_u32 s63, s36, s52
    s_and_b32 s29, s28, 3
    s_lshr_b32 s30, s28, 2
    s_cmp_eq_u32 s30, 0
    s_cbranch_scc1 Lload
Ltour_b:
    s_lshl_b32 s36, s51, 2
    s_add_u32 s36, s36, s29
    s_bitset1_b32 s36, 8
    s_mov_b64 exec, 0
Ltour:
    s_bitcmp1_b32 s36, 4
    s_cbranch_scc1 Ltree4_0
    s_bitcmp1_b32 s36, 3
    s_cbranch_scc1 Ltree3_0
    s_bitcmp1_b32 s36, 2
    s_cbranch_scc1 Ltree2_0
    s_bitcmp1_b32 s36, 1
    s_cbranch_scc1 Ltree1_0
    s_bitcmp1_b32 s36, 0
    s_cbranch_scc1 Lstop5
    s_branch Lstop3
Ltree1_0:
    s_bitcmp1_b32 s36, 0
    s_cbranch_scc1 Lstop10
    s_branch Lstop8
Ltree2_0:
    s_bitcmp1_b32 s36, 1
    s_cbranch_scc1 Ltree1_4
    s_bitcmp1_b32 s36, 0
    s_cbranch_scc1 Lstop1
    s_branch Lstop0
Ltree1_4:
    s_bitcmp1_b32 s36, 0
    s_cbranch_scc1 Lstop4
    s_branch Lstop2
Ltree3_0:
    s_bitcmp1_b32 s36, 2
    s_cbranch_scc1 Ltree2_8
    s_bitcmp1_b32 s36, 1
    s_cbranch_scc1 Ltree1_8
    s_bitcmp1_b32 s36, 0
    s_cbranch_scc1 Lstop7
    s_branch Lstop6
Ltree1_8:
    s_bitcmp1_b32 s36, 0
    s_cbranch_scc1 Lstop11
    s_branch Lstop9
Ltree2_8:
    s_bitcmp1_b32 s36, 1
    s_cbranch_scc1 Ltree1_12
    s_bitcmp1_b32 s36, 0
    s_cbranch_scc1 Lstop13
    s_branch Lstop12
Ltree1_12:
    s_bitcmp1_b32 s36, 0
    s_cbranch_scc1 Lstop15
    s_branch Lstop14
Ltree4_0:
    s_bitcmp1_b32 s36, 3
    s_cbranch_scc1 Ltree3_16
    s_bitcmp1_b32 s36, 2
    s_cbranch_scc1 Ltree2_16
    s_bitcmp1_b32 s36, 1
    s_cbranch_scc1 Ltree1_16
    s_bitcmp1_b32 s36, 0
    s_cbranch_scc1 Lstop17
    s_branch Lstop16
Ltree1_16:
    s_bitcmp1_b32 s36, 0
    s_cbranch_scc1 Lstop19
    s_branch Lstop18
Ltree2_16:
    s_bitcmp1_b32 s36, 1
    s_cbranch_scc1 Ltree1_20
    s_bitcmp1_b32 s36, 0
    s_cbranch_scc1 Lstop21
    s_branch Lstop20
Ltree1_20:
    s_bitcmp1_b32 s36, 0
    s_cbranch_scc1 Lstop23
    s_branch Lstop22
Ltree3_16:
    s_bitcmp1_b32 s36, 2
    s_cbranch_scc1 Ltree2_24
    s_bitcmp1_b32 s36, 1
    s_cbranch_scc1 Ltree1_24
    s_bitcmp1_b32 s36, 0
    s_cbranch_scc1 Lstop25
    s_branch Lstop24
Ltree1_24:
    s_bitcmp1_b32 s36, 0
    s_cbranch_scc1 Lstop27
    s_branch Lstop26
Ltree2_24:
    s_bitcmp1_b32 s36, 1
    s_cbranch_scc1 Ltree1_28
    s_bitcmp1_b32 s36, 0
    s_cbranch_scc1 Lstop29
    s_branch Lstop28
Ltree1_28:
    s_bitcmp1_b32 s36, 0
    s_cbranch_scc1 Ltour_ret
    s_branch Lstop30
Ltour_ret:
    s_bitcmp1_b32 s36, 8
    s_mov_b32 s36, s29
    s_cbranch_scc1 Ltour
    s_mov_b64 exec, -1
Ltour_e:
    s_branch Lcomp
Lload:
    s_mul_i32 s36, s52, 2
    s_mul_i32 s35, s35, 0
    s_add_u32 s36, s36, s35
    s_mul_i32 s35, s31, 3
    s_add_u32 s36, s36, s35
    s_mul_i32 s37, s36, 37
    s_lshr_b32 s37, s37, 8
    s_mul_i32 s37, s37, 7
    s_sub_u32 s34, s36, s37
    v_lshrrev_b32 v3, 3, v2
    v_and_b32 v4, 7, v2
    v_lshrrev_b32 v5, 4, v2
    v_xor_b32 v6, v4, v5
    v_mul_u32_u24 v15, 896, v3
    v_lshl_add_u32 v8, v6, 4, v15
    v_xor_b32 v6, 4, v6
    v_lshl_add_u32 v9, v6, 4, v15
    v_add_u32 v10, 12288, v8
    v_add_u32 v11, 18432, v9
    v_add_u32 v9, 6144, v9
    v_and_b32 v4, 3, v2
    v_lshlrev_b32 v4, 4, v4
    v_min_u32 v4, 40, v4
    v_lshrrev_b32 v6, 2, v2
    v_mul_u32_u24 v15, 2688, v6
    v_add_u32 v14, v15, v4
    v_xor_b32 v6, v6, v5
    v_and_b32 v6, 1, v6
    v_mul_u32_u24 v6, 56, v6
    v_mul_u32_u24 v15, 2688, v3
    v_add3_u32 v12, v15, v6, v4
    v_add_u32 v13, 20480, v12
    s_mul_i32 s48, s31, 114688
    s_mul_i32 s35, s29, 28672
    s_add_u32 s48, s48, s35
    s_mul_i32 s41, s29, 43008
    s_mul_i32 s42, s32, 56
    s_add_u32 s42, s42, s41
    s_mul_i32 s35, s63, 112
    s_add_u32 s41, s41, s35
    s_add_u32 s41, s41, 896
    s_lshl_b32 s43, s29, 12
    s_lshl_b32 s44, s29, 11
    s_lshl_b32 s45, s29, 10
    s_mov_b32 s46, s34
    s_mov_b32 s10, 1835008
    s_mov_b32 s11, 0x00020000
    s_mov_b32 s14, 1204224
    s_mov_b32 s15, 0x00020000
    s_mov_b32 s18, 16777216
    s_mov_b32 s19, 0x00020000
    s_waitcnt lgkmcnt(0)
    s_mov_b64 s[8:9], s[64:65]
    s_mov_b64 s[12:13], s[66:67]
    s_mov_b64 s[16:17], s[84:85]
    s_load_dword s33, s[84:85], 0
    s_mul_i32 s35, s46, 172032
    s_add_u32 s35, s35, s41
    s_add_u32 m0, s44, 65536
    s_lshl_b32 s36, s46, 7
    buffer_load_dwordx4 v12, s[12:15], s35 offen lds
    buffer_load_dwordx4 v13, s[12:15], s35 offen offset:1024 lds
    s_add_u32 m0, s43, 0
    s_add_u32 s36, s36, s48
    buffer_load_dwordx4 v8, s[8:11], s36 offen offset:0 lds
    buffer_load_dwordx4 v9, s[8:11], s36 offen offset:1024 lds
    buffer_load_dwordx4 v10, s[8:11], s36 offen offset:2048 lds
    buffer_load_dwordx4 v11, s[8:11], s36 offen offset:3072 lds
    s_add_u32 s46, s46, 1
    s_cmp_eq_u32 s46, 7
    s_cselect_b32 s46, 0, s46
    s_mov_b32 s58, 50000
    s_mov_b32 s56, 0
    s_mov_b32 s57, 0x3f803f80
    v_lshlrev_b32 v7, 4, v2
    s_lshl_b32 s35, s52, 16
    s_lshr_b32 s36, s51, 4
    s_lshl_b32 s36, s36, 19
    s_add_u32 s35, s35, s36
    s_lshl_b32 s36, s31, 12
    s_add_u32 s35, s35, s36
    s_add_u32 s35, s35, s45
    s_add_u32 s35, s35, 1048576
    v_and_b32 v28, 7, v2
    v_lshl_add_u32 v29, v28, 7, s35
    s_lshl_b32 s35, s52, 2
    s_add_u32 s35, s35, s29
    s_lshl_b32 s35, s35, 8
    s_add_u32 s49, s35, 12288
    s_lshl_b32 s36, s52, 8
    s_add_u32 s47, s36, 8192
    s_and_b32 s35, s51, 3
    s_lshl_b32 s35, s35, 6
    s_add_u32 s36, s35, s47
    s_add_u32 s35, s35, s49
    s_load_dword s61, s[84:85], s35
    s_load_dword s61, s[84:85], s36
    v_and_b32 v28, 1, v2
    s_mov_b32 exec_lo, 0
    v_lshl_add_u32 v29, v28, 7, s49
    s_mov_b32 exec_hi, 0xffff
    v_lshl_add_u32 v29, v28, 7, s47
    s_mov_b64 exec, -1
    s_getreg_b32 s50, hwreg(HW_REG_XCC_ID, 0, 4)
    v_mov_b32 v20, 0
    v_lshlrev_b32 v23, 2, v2
    v_add_u32 v21, 156672, v23
    ds_write_b32 v21, v20
    v_mov_b32 v21, 156676
    v_mov_b32 v20, 1
    v_and_b32 v3, 31, v2
    v_lshrrev_b32 v4, 5, v2
    v_bfe_u32 v5, v2, 1, 3
    v_xor_b32 v5, v5, v4
    v_lshlrev_b32 v5, 4, v5
    v_lshl_add_u32 v5, v3, 7, v5
    v_add_u32 v60, s43, v5
    v_xor_b32 v61, 32, v60
    v_xor_b32 v62, 64, v60
    v_xor_b32 v63, 96, v60
    v_lshlrev_b32 v119, 4, v4
    v_lshl_add_u32 v119, v3, 5, v119
    v_add_u32 v119, 160256, v119
    v_lshrrev_b32 v4, 5, v2
    v_bfe_u32 v5, v2, 2, 2
    v_lshl_add_u32 v6, v4, 3, v5
    v_bfe_u32 v24, v2, 4, 1
    v_and_b32 v25, 3, v2
    v_lshl_add_u32 v24, v24, 2, v25
    v_add_u32 v25, 2, v24
    v_lshrrev_b32 v25, 3, v25
    v_xor_b32 v24, v24, v25
    v_lshlrev_b32 v25, 3, v24
    v_lshl_add_u32 v24, v6, 7, v25
    v_lshrrev_b32 v5, 1, v5
    v_lshl_add_u32 v24, v5, 6, v24
    s_add_u32 s36, s44, 65536
Lstop0:
    s_cbranch_execz Ltour_ret
    v_add_u32 v24, s36, v24
    v_xor_b32 v31, 64, v24
    v_and_b32 v22, 15, v2
    v_lshl_add_u32 v22, v4, 4, v22
    s_lshl_b32 s35, s29, 3
    s_add_u32 s35, s35, 160256
    v_lshl_add_u32 v22, v22, 5, s35
    v_lshl_add_u32 v26, v6, 6, v25
    v_add_u32 v26, 98304, v26
    v_add_u32 v30, s45, v26
    v_and_b32 v27, 31, v2
    v_lshlrev_b32 v27, 3, v27
    s_lshl_b32 s35, s29, 2
    s_add_u32 s35, s35, 157248
    v_mov_b32 v18, s35
    v_mov_b32 v52, 0
    s_mov_b32 exec_lo, 0xff0000ff
    s_mov_b32 exec_hi, 0xff0000ff
    v_mov_b32 v52, s57
    s_mov_b64 exec, -1
    v_mov_b32 v53, v52
    v_mov_b32 v54, v52
    v_mov_b32 v55, v52
    s_mul_i32 s35, s51, 37
    s_lshr_b32 s35, s35, 8
    s_mul_i32 s36, s35, 7
    s_sub_u32 s54, s51, s36
    s_lshl_b32 s36, s52, 2
    s_add_u32 s55, s36, s54
    s_min_u32 s35, s35, 3
    s_add_u32 s53, s36, s35
    s_lshl_b32 s35, s32, 3
    s_add_u32 s35, s35, s29
    s_lshl_b32 s36, s35, 12
    s_add_u32 s39, s36, 1048576
    s_lshl_b32 s35, s32, 6
    s_add_u32 s35, s35, s29
    s_lshl_b32 s36, s31, 2
    s_add_u32 s35, s35, s36
    s_lshl_b32 s36, s35, 11
    s_add_u32 s3, s36, 6291456
    s_lshl_b32 s36, s35, 8
    s_add_u32 s4, s36, 786432
    s_lshl_b32 s36, s53, 1
    s_lshr_b32 s35, s29, 1
    s_add_u32 s35, s35, s36
    s_lshl_b32 s35, s35, 8
    s_lshr_b32 s36, s52, 2
    s_xor_b32 s36, s36, 1
    s_lshl_b32 s36, s36, 17
    s_add_u32 s35, s35, s36
    s_add_u32 s5, s35, 786432
    v_bfe_u32 v1, v2, 1, 3
    v_and_b32 v3, 1, v2
    v_lshlrev_b32 v1, 14, v1
    v_lshl_add_u32 v115, v3, 7, v1
    s_mul_i32 s35, s28, 12288
    v_add_u32 v113, s35, v7
    v_mov_b32 v120, 0
    v_mov_b32 v121, 0
    v_mov_b32 v122, 0
    v_mov_b32 v123, 0
    s_lshl_b32 s35, s52, 2
    s_add_u32 s35, s35, s29
    s_lshl_b32 s35, s35, 8
    s_add_u32 s38, s35, 12288
    s_mul_i32 s35, s31, 43
    s_lshr_b32 s35, s35, 8
    s_mul_i32 s35, s35, 6
    s_sub_u32 s40, s31, s35
    s_lshl_b32 s35, s53, 2
    s_add_u32 s35, s35, s29
    s_lshl_b32 s36, s35, 4
    v_lshrrev_b32 v1, 3, v2
    v_mul_u32_u24 v112, 896, v1
    s_mulk_i32 s36, 896
    v_and_b32 v3, 0x70, v7
    v_add3_u32 v127, v112, v3, s36
    s_and_b32 s36, s29, 1
    s_lshl_b32 s37, s36, 6
    v_xor_b32 v3, s37, v3
    v_and_b32 v1, 16, v2
    v_lshlrev_b32 v1, 1, v1
    v_xor_b32 v3, v1, v3
    v_add_u32 v112, v112, v3
    s_lshl_b32 s36, s36, 8
    v_and_b32 v1, 0xf0, v7
    v_and_b32 v3, 0x300, v7
    v_lshl_add_u32 v1, v3, 1, v1
    v_add_u32 v124, s36, v1
    s_lshl_b32 s71, s54, 7
    s_mul_i32 s36, s28, 6272
    s_mul_i32 s70, s28, 896
    s_mov_b32 s20, s68
    s_mov_b32 s21, s69
    s_mov_b32 s22, 401408
    s_mov_b32 s23, 0x00020000
    s_lshl_b32 s37, s51, 3
    s_add_u32 s37, s37, s28
    s_mulk_i32 s37, 1664
    v_min_u32 v1, 12, v2
    v_lshl_add_u32 v117, v1, 7, s37
    s_lshl_b32 s35, s35, 11
    s_add_u32 s35, s35, s71
    s_add_u32 s35, s35, s71
    s_add_u32 s35, s35, 524288
    s_lshl_b32 s37, s2, 2
    s_add_u32 s37, s37, s29
    s_lshl_b32 s37, s37, 9
    v_and_b32 v1, 3, v2
    v_lshl_add_u32 v114, v1, 7, s37
    v_and_b32 v1, 1, v2
    v_lshl_add_u32 v1, v1, 7, s35
    s_mov_b32 exec_lo, 0
    v_mov_b32 v114, v1
    s_mov_b32 exec_lo, -1
    s_add_u32 s71, s71, s36
    s_mov_b32 s24, s84
    s_mov_b32 s25, s85
    s_mov_b32 s26, 16777216
    s_mov_b32 s27, 0x00020000
    v_lshrrev_b32 v111, 4, v2
    v_bfe_u32 v108, v2, 2, 2
    v_and_b32 v1, 3, v2
    v_mul_u32_u24 v105, 896, v111
    v_lshl_add_u32 v105, v1, 3, v105
    v_and_b32 v1, 1, v111
    v_lshl_add_u32 v105, v1, 6, v105
    v_lshrrev_b32 v1, 1, v108
    v_lshl_add_u32 v105, v1, 5, v105
    v_add_u32 v105, 98304, v105
    v_lshl_add_u32 v96, v108, 7, v105
    v_min_u32 v108, 2, v108
    v_lshl_add_u32 v100, v108, 7, v105
    v_xor_b32 v97, 32, v96
    v_xor_b32 v101, 32, v100
    v_xor_b32 v98, 64, v96
    v_xor_b32 v102, 64, v100
    v_xor_b32 v99, 96, v96
    v_xor_b32 v103, 96, v100
    s_lshl_b32 s36, s29, 12
    s_add_u32 s35, s36, 32768
    v_add_u32 v104, s35, v7
    s_add_u32 s35, s36, 49152
    v_and_b32 v109, 15, v2
    v_mul_u32_u24 v106, 144, v109
    v_lshl_add_u32 v106, v111, 3, v106
    v_add_u32 v106, s35, v106
    v_lshrrev_b32 v1, 3, v2
    v_lshl_add_u32 v1, v1, 4, v7
    v_add_u32 v105, s35, v1
    v_lshlrev_b32 v110, 4, v111
    v_add_u32 v1, 1, v111
    v_lshrrev_b32 v1, 2, v1
    v_lshl_add_u32 v107, v1, 30, v7
    v_lshlrev_b32 v1, 4, v109
    v_add_u32 v111, 156928, v1
    s_lshl_b32 s35, s29, 4
    v_add_u32 v109, s35, v109
    v_lshlrev_b32 v108, 2, v109
    v_add_u32 v108, 156928, v108
    s_mul_i32 s35, s46, 172032
    s_add_u32 s35, s35, s41
    s_add_u32 m0, s44, 73728
    s_lshl_b32 s36, s46, 7
    buffer_load_dwordx4 v12, s[12:15], s35 offen lds
    buffer_load_dwordx4 v13, s[12:15], s35 offen offset:1024 lds
    s_add_u32 m0, s43, 16384
    s_add_u32 s36, s36, s48
    buffer_load_dwordx4 v8, s[8:11], s36 offen offset:0 lds
    buffer_load_dwordx4 v9, s[8:11], s36 offen offset:1024 lds
    buffer_load_dwordx4 v10, s[8:11], s36 offen offset:2048 lds
    buffer_load_dwordx4 v11, s[8:11], s36 offen offset:3072 lds
    s_add_u32 s46, s46, 1
    s_cmp_eq_u32 s46, 7
    s_cselect_b32 s46, 0, s46
    s_mul_i32 s35, s34, 172032
    s_add_u32 m0, s45, 98304
    s_add_u32 s35, s35, s42
    buffer_load_dwordx4 v14, s[12:15], s35 offen lds
    s_add_u32 s34, s34, 1
    s_cmp_eq_u32 s34, 7
    s_cselect_b32 s34, 0, s34
    s_waitcnt vmcnt(7) lgkmcnt(0)
    s_barrier
    ds_read_b64_tr_b16 v[32:33], v24 offset:0
    ds_read_b64_tr_b16 v[34:35], v24 offset:512
    ds_read_b64_tr_b16 v[36:37], v31 offset:0
    ds_read_b64_tr_b16 v[38:39], v31 offset:512
    s_mul_i32 s33, s33, 0x9e3779b1
    s_add_u32 s33, s33, 0x7f4a7c15
    s_lshl_b32 s35, s51, 3
    s_add_u32 s35, s35, s47
    v_mov_b32 v16, s33
    v_mov_b32 v17, s50
    s_mov_b64 exec, 1
    buffer_store_dwordx2 v[16:17], v120, s[16:19], s35 offen
    s_mov_b64 exec, -1
    ds_read_b128 v[128:131], v60 offset:0
    ds_read_b128 v[132:135], v61 offset:0
    ds_read_b128 v[136:139], v62 offset:0
    ds_read_b128 v[140:143], v63 offset:0
    s_mul_i32 s35, s46, 172032
    s_add_u32 s35, s35, s41
    s_add_u32 m0, s44, 81920
    s_lshl_b32 s36, s46, 7
    buffer_load_dwordx4 v12, s[12:15], s35 offen lds
    buffer_load_dwordx4 v13, s[12:15], s35 offen offset:1024 lds
    s_add_u32 m0, s43, 32768
    s_add_u32 s36, s36, s48
    buffer_load_dwordx4 v8, s[8:11], s36 offen offset:0 lds
    buffer_load_dwordx4 v9, s[8:11], s36 offen offset:1024 lds
    buffer_load_dwordx4 v10, s[8:11], s36 offen offset:2048 lds
    buffer_load_dwordx4 v11, s[8:11], s36 offen offset:3072 lds
    s_add_u32 s46, s46, 1
    s_cmp_eq_u32 s46, 7
    s_cselect_b32 s46, 0, s46
    s_waitcnt lgkmcnt(0)
    v_mfma_f32_16x16x32_bf16 v[48:51], v[52:55], v[32:35], 0
    v_mfma_f32_16x16x32_bf16 v[56:59], v[52:55], v[36:39], 0
Lstop1:
    s_cbranch_execz Ltour_ret
    s_waitcnt vmcnt(8) lgkmcnt(0)
    s_barrier
    ds_read_b64_tr_b16 v[32:33], v24 offset:8192
    ds_read_b64_tr_b16 v[34:35], v24 offset:8704
    ds_read_b64_tr_b16 v[36:37], v31 offset:8192
    ds_read_b64_tr_b16 v[38:39], v31 offset:8704
    ds_read_b128 v[144:147], v60 offset:16384
    ds_read_b128 v[148:151], v61 offset:16384
    ds_read_b128 v[152:155], v62 offset:16384
    ds_read_b128 v[156:159], v63 offset:16384
    s_mul_i32 s35, s46, 172032
    s_add_u32 s35, s35, s41
    s_add_u32 m0, s44, 90112
    s_lshl_b32 s36, s46, 7
    buffer_load_dwordx4 v12, s[12:15], s35 offen lds
    buffer_load_dwordx4 v13, s[12:15], s35 offen offset:1024 lds
    s_add_u32 m0, s43, 49152
    s_add_u32 s36, s36, s48
    buffer_load_dwordx4 v8, s[8:11], s36 offen offset:0 lds
    buffer_load_dwordx4 v9, s[8:11], s36 offen offset:1024 lds
    buffer_load_dwordx4 v10, s[8:11], s36 offen offset:2048 lds
    buffer_load_dwordx4 v11, s[8:11], s36 offen offset:3072 lds
    s_add_u32 s46, s46, 1
    s_cmp_eq_u32 s46, 7
    s_cselect_b32 s46, 0, s46
    s_waitcnt lgkmcnt(0)
    v_mfma_f32_16x16x32_bf16 v[48:51], v[52:55], v[32:35], v[48:51]
    v_mfma_f32_16x16x32_bf16 v[56:59], v[52:55], v[36:39], v[56:59]
    s_waitcnt vmcnt(6) lgkmcnt(0)
    s_barrier
    ds_read_b64_tr_b16 v[32:33], v24 offset:16384
    ds_read_b64_tr_b16 v[34:35], v24 offset:16896
    ds_read_b64_tr_b16 v[36:37], v31 offset:16384
    ds_read_b64_tr_b16 v[38:39], v31 offset:16896
    ds_read_b128 v[160:163], v60 offset:32768
    ds_read_b128 v[164:167], v61 offset:32768
    ds_read_b128 v[168:171], v62 offset:32768
    ds_read_b128 v[172:175], v63 offset:32768
    ds_read_b64_tr_b16 v[80:81], v26 offset:0
    ds_read_b64_tr_b16 v[82:83], v26 offset:256
    s_mul_i32 s35, s46, 172032
    s_add_u32 s35, s35, s41
    s_add_u32 m0, s44, 65536
    s_lshl_b32 s36, s46, 7
    buffer_load_dwordx4 v12, s[12:15], s35 offen lds
    buffer_load_dwordx4 v13, s[12:15], s35 offen offset:1024 lds
    s_add_u32 m0, s43, 0
    s_add_u32 s36, s36, s48
    buffer_load_dwordx4 v8, s[8:11], s36 offen offset:0 lds
    buffer_load_dwordx4 v9, s[8:11], s36 offen offset:1024 lds
    buffer_load_dwordx4 v10, s[8:11], s36 offen offset:2048 lds
    buffer_load_dwordx4 v11, s[8:11], s36 offen offset:3072 lds
    s_add_u32 s46, s46, 1
    s_cmp_eq_u32 s46, 7
    s_cselect_b32 s46, 0, s46
    s_waitcnt lgkmcnt(0)
    v_mfma_f32_16x16x32_bf16 v[48:51], v[52:55], v[32:35], v[48:51]
    v_mfma_f32_16x16x32_bf16 v[56:59], v[52:55], v[36:39], v[56:59]
    v_mfma_f32_32x32x16_bf16 v[64:79], v[80:83], v[128:131], 0
    s_waitcnt vmcnt(6) lgkmcnt(0)
    s_barrier
    ds_read_b64_tr_b16 v[32:33], v24 offset:24576
    ds_read_b64_tr_b16 v[34:35], v24 offset:25088
    ds_read_b64_tr_b16 v[36:37], v31 offset:24576
    ds_read_b64_tr_b16 v[38:39], v31 offset:25088
    ds_read_b128 v[176:179], v60 offset:49152
    ds_read_b128 v[180:183], v61 offset:49152
    ds_read_b128 v[184:187], v62 offset:49152
    ds_read_b128 v[188:191], v63 offset:49152
    ds_read_b64_tr_b16 v[80:81], v26 offset:1024
    ds_read_b64_tr_b16 v[82:83], v26 offset:1280
    buffer_load_dwordx2 v[46:47], v27, s[16:19], s47 offen sc1
    s_mul_i32 s35, s46, 172032
    s_add_u32 s35, s35, s41
    s_add_u32 m0, s44, 73728
    s_lshl_b32 s36, s46, 7
    buffer_load_dwordx4 v12, s[12:15], s35 offen lds
    buffer_load_dwordx4 v13, s[12:15], s35 offen offset:1024 lds
    s_add_u32 m0, s43, 16384
    s_add_u32 s36, s36, s48
    buffer_load_dwordx4 v8, s[8:11], s36 offen offset:0 lds
    buffer_load_dwordx4 v9, s[8:11], s36 offen offset:1024 lds
    buffer_load_dwordx4 v10, s[8:11], s36 offen offset:2048 lds
    buffer_load_dwordx4 v11, s[8:11], s36 offen offset:3072 lds
    s_add_u32 s46, s46, 1
    s_cmp_eq_u32 s46, 7
    s_cselect_b32 s46, 0, s46
    s_waitcnt lgkmcnt(0)
    v_mfma_f32_16x16x32_bf16 v[48:51], v[52:55], v[32:35], v[48:51]
    v_mfma_f32_16x16x32_bf16 v[56:59], v[52:55], v[36:39], v[56:59]
    v_mfma_f32_32x32x16_bf16 v[64:79], v[80:83], v[132:135], v[64:79]
    s_waitcnt vmcnt(7) lgkmcnt(0)
    s_barrier
    ds_read_b64_tr_b16 v[32:33], v24 offset:0
    ds_read_b64_tr_b16 v[34:35], v24 offset:512
    ds_read_b64_tr_b16 v[36:37], v31 offset:0
    ds_read_b64_tr_b16 v[38:39], v31 offset:512
    ds_read_b128 v[192:195], v60 offset:0
    ds_read_b128 v[196:199], v61 offset:0
    ds_read_b128 v[200:203], v62 offset:0
    ds_read_b128 v[204:207], v63 offset:0
    ds_read_b64_tr_b16 v[80:81], v26 offset:2048
    ds_read_b64_tr_b16 v[82:83], v26 offset:2304
    s_mul_i32 s35, s46, 172032
    s_add_u32 s35, s35, s41
    s_add_u32 m0, s44, 81920
    s_lshl_b32 s36, s46, 7
    buffer_load_dwordx4 v12, s[12:15], s35 offen lds
    buffer_load_dwordx4 v13, s[12:15], s35 offen offset:1024 lds
    s_add_u32 m0, s43, 32768
    s_add_u32 s36, s36, s48
    buffer_load_dwordx4 v8, s[8:11], s36 offen offset:0 lds
    buffer_load_dwordx4 v9, s[8:11], s36 offen offset:1024 lds
    buffer_load_dwordx4 v10, s[8:11], s36 offen offset:2048 lds
    buffer_load_dwordx4 v11, s[8:11], s36 offen offset:3072 lds
    buffer_load_dword v118, v29, s[16:19], 0 offen sc1
    s_waitcnt lgkmcnt(0)
    v_mfma_f32_16x16x32_bf16 v[48:51], v[52:55], v[32:35], v[48:51]
    v_mfma_f32_16x16x32_bf16 v[56:59], v[52:55], v[36:39], v[56:59]
    v_mfma_f32_32x32x16_bf16 v[64:79], v[80:83], v[136:139], v[64:79]
    s_waitcnt vmcnt(7) lgkmcnt(0)
    s_barrier
    ds_read_b64_tr_b16 v[32:33], v24 offset:8192
    ds_read_b64_tr_b16 v[34:35], v24 offset:8704
    ds_read_b64_tr_b16 v[36:37], v31 offset:8192
    ds_read_b64_tr_b16 v[38:39], v31 offset:8704
    ds_read_b128 v[208:211], v60 offset:16384
    ds_read_b128 v[212:215], v61 offset:16384
    ds_read_b128 v[216:219], v62 offset:16384
    ds_read_b128 v[220:223], v63 offset:16384
    ds_read_b64_tr_b16 v[80:81], v26 offset:3072
    ds_read_b64_tr_b16 v[82:83], v26 offset:3328
    s_mul_i32 s35, s34, 172032
    s_add_u32 m0, s45, 102400
    s_add_u32 s35, s35, s42
    buffer_load_dwordx4 v14, s[12:15], s35 offen lds
    s_add_u32 s34, s34, 1
    s_cmp_eq_u32 s34, 7
    s_cselect_b32 s34, 0, s34
    s_mul_i32 s35, s34, 172032
    s_add_u32 m0, s45, 106496
    s_add_u32 s35, s35, s42
    buffer_load_dwordx4 v14, s[12:15], s35 offen lds
    s_add_u32 s34, s34, 1
    s_cmp_eq_u32 s34, 7
    s_cselect_b32 s34, 0, s34
    s_mul_i32 s35, s34, 172032
    s_add_u32 m0, s45, 110592
    s_add_u32 s35, s35, s42
    buffer_load_dwordx4 v14, s[12:15], s35 offen lds
    s_add_u32 s34, s34, 1
    s_cmp_eq_u32 s34, 7
    s_cselect_b32 s34, 0, s34
    v_cmp_ne_u32 vcc, s33, v46
    v_cmp_ne_u32 s[36:37], s50, v47
    s_or_b64 vcc, vcc, s[36:37]
    s_cselect_b32 s7, 0, 1
    v_mov_b32 v19, s7
    ds_write_b32 v18, v19
    s_waitcnt lgkmcnt(0)
    v_mfma_f32_16x16x32_bf16 v[48:51], v[52:55], v[32:35], v[48:51]
    v_mfma_f32_16x16x32_bf16 v[56:59], v[52:55], v[36:39], v[56:59]
    v_mfma_f32_32x32x16_bf16 v[64:79], v[80:83], v[140:143], v[64:79]
    s_waitcnt vmcnt(4) lgkmcnt(0)
    s_barrier
    ds_read_b64_tr_b16 v[32:33], v24 offset:16384
    ds_read_b64_tr_b16 v[34:35], v24 offset:16896
    ds_read_b64_tr_b16 v[36:37], v31 offset:16384
    ds_read_b64_tr_b16 v[38:39], v31 offset:16896
    s_waitcnt lgkmcnt(0)
    v_mfma_f32_16x16x32_bf16 v[48:51], v[52:55], v[32:35], v[48:51]
    v_mfma_f32_16x16x32_bf16 v[56:59], v[52:55], v[36:39], v[56:59]
    ds_read_b128 v[224:227], v60 offset:32768
    ds_read_b128 v[228:231], v61 offset:32768
    ds_read_b128 v[232:235], v62 offset:32768
    ds_read_b128 v[236:239], v63 offset:32768
    s_mov_b32 s37, 0x07060302
    s_nop 1
    v_and_b32 v49, 0xffff0000, v48
    v_and_b32 v57, 0xffff0000, v56
Lstop2:
    s_cbranch_execz Ltour_ret
    v_sub_f32 v49, v48, v49
    v_sub_f32 v57, v56, v57
    v_and_b32 v50, 0xffff0000, v49
    v_perm_b32 v48, v49, v48, s37
    v_and_b32 v58, 0xffff0000, v57
    v_perm_b32 v56, v57, v56, s37
    v_sub_f32 v49, v49, v50
    v_sub_f32 v57, v57, v58
    v_lshrrev_b32 v49, 16, v49
    ds_write_b64 v22, v[48:49] offset:0
    v_lshrrev_b32 v57, 16, v57
    ds_write_b64 v22, v[56:57] offset:1024
    s_mul_i32 s35, s34, 172032
    s_add_u32 m0, s45, 114688
    s_add_u32 s35, s35, s42
    buffer_load_dwordx4 v14, s[12:15], s35 offen lds
    s_add_u32 s34, s34, 1
    s_cmp_eq_u32 s34, 7
    s_cselect_b32 s34, 0, s34
    s_mul_i32 s35, s34, 172032
    s_add_u32 m0, s45, 118784
    s_add_u32 s35, s35, s42
    buffer_load_dwordx4 v14, s[12:15], s35 offen lds
    s_add_u32 s34, s34, 1
    s_cmp_eq_u32 s34, 7
    s_cselect_b32 s34, 0, s34
    s_mul_i32 s35, s34, 172032
    s_add_u32 m0, s45, 122880
    s_add_u32 s35, s35, s42
    buffer_load_dwordx4 v14, s[12:15], s35 offen lds
    s_waitcnt vmcnt(63) lgkmcnt(0)
    s_barrier
    s_waitcnt vmcnt(3)
    s_mov_b64 exec, 1
    ds_add_u32 v21, v20 offset:0
    s_mov_b64 exec, -1
    v_add_u32 v3, s44, v7
    s_lshl_b32 s35, s29, 9
    s_add_u32 s35, s35, 157696
    v_lshl_add_u32 v5, v2, 3, s35
    s_sub_u32 s35, s5, 786432
    s_lshl_b32 s35, s35, 3
    s_add_u32 s35, s35, 6291456
    s_mov_b32 s36, 0
    s_lshl_b32 s37, s36, 19
    s_sub_u32 s34, s35, s37
    s_add_u32 s6, s35, s37
    s_mul_i32 s35, s36, 14336
    s_lshl_b32 s48, s35, 1
    s_bfe_u32 s36, s5, 0x10011
    s_mulk_i32 s36, 28672
    s_add_u32 s35, s35, s36
    v_add_u32 v96, s35, v96
    v_add_u32 v97, s35, v97
    v_add_u32 v98, s35, v98
    v_add_u32 v99, s35, v99
    v_add_u32 v100, s35, v100
    v_add_u32 v101, s35, v101
    v_add_u32 v102, s35, v102
    v_add_u32 v103, s35, v103
    s_lshl_b32 s36, s53, 6
    v_add_u32 v109, s36, v109
    s_lshl_b32 s35, s29, 4
    s_add_u32 s35, s35, s36
    s_lshl_b32 s35, s35, 7
    s_add_u32 s49, s35, 524288
    s_lshl_b32 s35, s54, 8
    s_lshl_b32 s36, s36, 7
    s_add_u32 s35, s35, s36
    s_add_u32 s50, s35, 262144
    s_brev_b32 s82, 1
    s_movk_i32 s83, 0xf800
    s_mov_b32 s37, 0x07060302
Lcnt_1:
    ds_read_b32 v19, v21 offset:0
    s_waitcnt lgkmcnt(0)
    v_cmp_gt_u32 vcc, 4, v19
    s_cbranch_vccnz Lcnt_1
    ds_read_b64_tr_b16 v[80:81], v26 offset:4096
    ds_read_b64_tr_b16 v[82:83], v26 offset:4352
    ds_read_b64_tr_b16 v[84:85], v26 offset:5120
    ds_read_b64_tr_b16 v[86:87], v26 offset:5376
Lstop3:
    s_cbranch_execz Lstop12
    ds_read_b64_tr_b16 v[88:89], v26 offset:6144
    ds_read_b64_tr_b16 v[90:91], v26 offset:6400
    ds_read_b64_tr_b16 v[92:93], v26 offset:7168
    ds_read_b64_tr_b16 v[94:95], v26 offset:7424
    ds_read_b64_tr_b16 v[240:241], v26 offset:8192
    ds_read_b64_tr_b16 v[242:243], v26 offset:8448
    ds_read_b64_tr_b16 v[244:245], v26 offset:9216
    ds_read_b64_tr_b16 v[246:247], v26 offset:9472
    s_waitcnt lgkmcnt(10)
    v_mfma_f32_32x32x16_bf16 v[64:79], v[80:83], v[144:147], v[64:79]
    ds_read_b64_tr_b16 v[248:249], v26 offset:10240
    ds_read_b64_tr_b16 v[250:251], v26 offset:10496
    s_waitcnt lgkmcnt(10)
    v_mfma_f32_32x32x16_bf16 v[64:79], v[84:87], v[148:151], v[64:79]
    ds_read_b64_tr_b16 v[252:253], v26 offset:11264
    ds_read_b64_tr_b16 v[254:255], v26 offset:11520
    s_waitcnt lgkmcnt(10)
    v_mfma_f32_32x32x16_bf16 v[64:79], v[88:91], v[152:155], v[64:79]
    ds_read_b64_tr_b16 v[80:81], v26 offset:12288
    ds_read_b64_tr_b16 v[82:83], v26 offset:12544
    s_waitcnt lgkmcnt(10)
    v_mfma_f32_32x32x16_bf16 v[64:79], v[92:95], v[156:159], v[64:79]
    ds_read_b64_tr_b16 v[84:85], v26 offset:13312
    ds_read_b64_tr_b16 v[86:87], v26 offset:13568
    s_waitcnt lgkmcnt(10)
    v_mfma_f32_32x32x16_bf16 v[64:79], v[240:243], v[160:163], v[64:79]
    ds_read_b64_tr_b16 v[88:89], v26 offset:14336
    ds_read_b64_tr_b16 v[90:91], v26 offset:14592
    s_waitcnt lgkmcnt(10)
    v_mfma_f32_32x32x16_bf16 v[64:79], v[244:247], v[164:167], v[64:79]
    ds_read_b64_tr_b16 v[92:93], v26 offset:15360
    ds_read_b64_tr_b16 v[94:95], v26 offset:15616
    s_waitcnt lgkmcnt(10)
    v_mfma_f32_32x32x16_bf16 v[64:79], v[248:251], v[168:171], v[64:79]
    ds_read_b64_tr_b16 v[32:33], v30 offset:0
    ds_read_b64_tr_b16 v[34:35], v30 offset:256
    s_waitcnt lgkmcnt(10)
    v_mfma_f32_32x32x16_bf16 v[64:79], v[252:255], v[172:175], v[64:79]
    ds_read_b64_tr_b16 v[36:37], v30 offset:4096
    ds_read_b64_tr_b16 v[38:39], v30 offset:4352
    s_waitcnt lgkmcnt(10)
    v_mfma_f32_32x32x16_bf16 v[64:79], v[80:83], v[176:179], v[64:79]
    ds_read_b64_tr_b16 v[40:41], v30 offset:8192
    ds_read_b64_tr_b16 v[42:43], v30 offset:8448
    s_waitcnt lgkmcnt(10)
    v_mfma_f32_32x32x16_bf16 v[64:79], v[84:87], v[180:183], v[64:79]
    ds_read_b64_tr_b16 v[44:45], v30 offset:12288
    ds_read_b64_tr_b16 v[46:47], v30 offset:12544
    s_waitcnt vmcnt(0)
    s_mov_b64 exec, 1
    ds_add_u32 v21, v20 offset:4
    s_mov_b64 exec, -1
    s_waitcnt lgkmcnt(11)
    v_mfma_f32_32x32x16_bf16 v[64:79], v[88:91], v[184:187], v[64:79]
    s_waitcnt lgkmcnt(9)
    v_mfma_f32_32x32x16_bf16 v[64:79], v[92:95], v[188:191], v[64:79]
    ds_read_b32 v19, v21 offset:4
    s_waitcnt lgkmcnt(8)
    v_mfma_f32_16x16x32_bf16 v[48:51], v[52:55], v[32:35], 0
    s_waitcnt lgkmcnt(6)
    v_mfma_f32_16x16x32_bf16 v[48:51], v[52:55], v[36:39], v[48:51]
    s_waitcnt lgkmcnt(0)
    v_cmp_gt_u32 vcc, 4, v19
    s_cbranch_vccnz Lq1
Lq1x:
    ds_read_b64_tr_b16 v[240:241], v26 offset:16384
    ds_read_b64_tr_b16 v[242:243], v26 offset:16640
    ds_read_b64_tr_b16 v[244:245], v26 offset:17408
    ds_read_b64_tr_b16 v[246:247], v26 offset:17664
    ds_read_b64_tr_b16 v[248:249], v26 offset:18432
    ds_read_b64_tr_b16 v[250:251], v26 offset:18688
    ds_read_b64_tr_b16 v[252:253], v26 offset:19456
    ds_read_b64_tr_b16 v[254:255], v26 offset:19712
    v_mfma_f32_16x16x32_bf16 v[48:51], v[52:55], v[40:43], v[48:51]
    v_mfma_f32_16x16x32_bf16 v[48:51], v[52:55], v[44:47], v[48:51]
    ds_read_b64_tr_b16 v[32:33], v30 offset:16384
    ds_read_b64_tr_b16 v[34:35], v30 offset:16640
    ds_read_b64_tr_b16 v[36:37], v30 offset:20480
    ds_read_b64_tr_b16 v[38:39], v30 offset:20736
    ds_read_b64_tr_b16 v[40:41], v30 offset:24576
    ds_read_b64_tr_b16 v[42:43], v30 offset:24832
    s_waitcnt lgkmcnt(12)
    v_mfma_f32_32x32x16_bf16 v[64:79], v[240:243], v[192:195], v[64:79]
    s_waitcnt lgkmcnt(10)
    v_mfma_f32_32x32x16_bf16 v[64:79], v[244:247], v[196:199], v[64:79]
    ds_read_b64_tr_b16 v[80:81], v26 offset:20480
    ds_read_b64_tr_b16 v[82:83], v26 offset:20736
    s_waitcnt lgkmcnt(10)
    v_mfma_f32_32x32x16_bf16 v[64:79], v[248:251], v[200:203], v[64:79]
    ds_read_b64_tr_b16 v[84:85], v26 offset:21504
    ds_read_b64_tr_b16 v[86:87], v26 offset:21760
    s_waitcnt lgkmcnt(8)
    v_mfma_f32_16x16x32_bf16 v[48:51], v[52:55], v[32:35], v[48:51]
    s_waitcnt lgkmcnt(6)
    v_mfma_f32_16x16x32_bf16 v[48:51], v[52:55], v[36:39], v[48:51]
    s_waitcnt lgkmcnt(4)
    v_mfma_f32_16x16x32_bf16 v[48:51], v[52:55], v[40:43], v[48:51]
    v_mfma_f32_32x32x16_bf16 v[64:79], v[252:255], v[204:207], v[64:79]
    ds_read_b64_tr_b16 v[88:89], v26 offset:22528
    ds_read_b64_tr_b16 v[90:91], v26 offset:22784
    ds_read_b64_tr_b16 v[92:93], v26 offset:23552
    ds_read_b64_tr_b16 v[94:95], v26 offset:23808
    ds_read_b64_tr_b16 v[240:241], v26 offset:24576
    ds_read_b64_tr_b16 v[242:243], v26 offset:24832
    ds_read_b64_tr_b16 v[244:245], v26 offset:25600
    ds_read_b64_tr_b16 v[246:247], v26 offset:25856
    s_waitcnt lgkmcnt(10)
    v_mfma_f32_32x32x16_bf16 v[64:79], v[80:83], v[208:211], v[64:79]
    ds_read_b64_tr_b16 v[248:249], v26 offset:26624
    ds_read_b64_tr_b16 v[250:251], v26 offset:26880
    v_and_b32 v49, 0xffff0000, v48
    v_sub_f32 v49, v48, v49
    v_and_b32 v50, 0xffff0000, v49
    v_perm_b32 v48, v49, v48, s37
    v_sub_f32 v49, v49, v50
    v_lshrrev_b32 v49, 16, v49
    ds_write_b64 v22, v[48:49] offset:2048
    s_mov_b64 exec, 1
    ds_add_u32 v21, v20 offset:8
    s_mov_b64 exec, -1
    s_waitcnt lgkmcnt(12)
    v_mfma_f32_32x32x16_bf16 v[64:79], v[84:87], v[212:215], v[64:79]
    s_waitcnt lgkmcnt(10)
    v_mfma_f32_32x32x16_bf16 v[64:79], v[88:91], v[216:219], v[64:79]
    ds_read_b64_tr_b16 v[252:253], v26 offset:27648
    ds_read_b64_tr_b16 v[254:255], v26 offset:27904
    s_waitcnt lgkmcnt(10)
    v_mfma_f32_32x32x16_bf16 v[64:79], v[92:95], v[220:223], v[64:79]
    s_waitcnt lgkmcnt(8)
    v_mfma_f32_32x32x16_bf16 v[64:79], v[240:243], v[224:227], v[64:79]
    ds_read_b32 v19, v21 offset:8
    s_waitcnt lgkmcnt(7)
    v_mfma_f32_32x32x16_bf16 v[64:79], v[244:247], v[228:231], v[64:79]
    s_waitcnt lgkmcnt(5)
    v_mfma_f32_32x32x16_bf16 v[64:79], v[248:251], v[232:235], v[64:79]
    s_waitcnt lgkmcnt(0)
    v_cmp_gt_u32 vcc, 8, v19
    s_cbranch_vccnz Lq2
Lq2x:
    ds_read_b64 v[40:41], v5
    ds_read_b128 v[36:39], v119 offset:2048
    v_mfma_f32_32x32x16_bf16 v[64:79], v[252:255], v[236:239], v[64:79]
    s_waitcnt lgkmcnt(1)
    v_mul_f32 v44, 0x3e8b97f6, v41
    v_mov_b32 v41, v40
    v_mov_b32 v42, v40
    v_mov_b32 v43, v40
    s_waitcnt lgkmcnt(0)
    s_nop 0
    v_mfma_f32_32x32x16_bf16 v[64:79], v[36:39], v[40:43], v[64:79]
    buffer_load_dword v26, v23, s[16:19], s38 offen sc1
    s_add_u32 s35, s29, 1
    s_and_b32 s44, s35, 3
    s_lshl_b32 s35, s44, 11
    v_add_u32 v16, s35, v7
    s_add_u32 s35, s29, 2
    s_and_b32 s45, s35, 3
    s_lshl_b32 s35, s45, 11
    v_add_u32 v17, s35, v7
    s_add_u32 s35, s29, 3
    s_and_b32 s46, s35, 3
    s_lshl_b32 s35, s46, 11
    v_add_u32 v18, s35, v7
    s_add_u32 s35, s29, 4
    s_and_b32 s47, s35, 3
    s_lshl_b32 s35, s47, 11
    v_add_u32 v19, s35, v7
    v_pk_mul_f32 v[64:65], v[64:65], v[44:45] op_sel_hi:[1,0]
    v_pk_mul_f32 v[66:67], v[66:67], v[44:45] op_sel_hi:[1,0]
    v_pk_mul_f32 v[68:69], v[68:69], v[44:45] op_sel_hi:[1,0]
    v_pk_mul_f32 v[70:71], v[70:71], v[44:45] op_sel_hi:[1,0]
    v_pk_mul_f32 v[72:73], v[72:73], v[44:45] op_sel_hi:[1,0]
    v_pk_mul_f32 v[74:75], v[74:75], v[44:45] op_sel_hi:[1,0]
    v_pk_mul_f32 v[76:77], v[76:77], v[44:45] op_sel_hi:[1,0]
    v_pk_mul_f32 v[78:79], v[78:79], v[44:45] op_sel_hi:[1,0]
    v_cvt_pk_bf16_f32 v8, v64, v65
    v_cvt_pk_bf16_f32 v9, v66, v67
    v_cvt_pk_bf16_f32 v10, v68, v69
    v_cvt_pk_bf16_f32 v11, v70, v71
    v_cvt_pk_bf16_f32 v12, v72, v73
    v_cvt_pk_bf16_f32 v13, v74, v75
    v_cvt_pk_bf16_f32 v14, v76, v77
    v_cvt_pk_bf16_f32 v15, v78, v79
    s_mov_b32 exec_lo, 0
    v_mov_b32 v14, 0xc220
    v_mov_b32 v15, 0
    s_mov_b32 exec_lo, -1
Lstop4:
    s_cbranch_execz Ltour_ret
    ds_write_b128 v3, v[8:11]
    ds_write_b128 v3, v[12:15] offset:1024
    s_waitcnt lgkmcnt(0)
    s_barrier
    s_setprio 3
    s_branch Lpoll0a
Lpoll0:
    buffer_load_dword v26, v23, s[16:19], s38 offen sc1
    s_sub_u32 s58, s58, 1
    s_bitcmp1_b32 s58, 31
    s_cbranch_scc1 Lpoll0x
Lpoll0a:
    s_waitcnt vmcnt(0)
    v_cmp_ne_u32 vcc, s33, v26
    s_and_b32 s35, vcc_lo, vcc_hi
    s_lshr_b32 s36, s35, 16
    s_or_b32 s35, s35, s36
    s_and_b32 s62, s35, 3
    s_cmp_eq_u32 s62, 3
    s_cbranch_scc1 Lpoll0
Lpoll0x:
    s_and_b32 s59, s62, 1
    s_lshl_b32 s59, s59, 19
    s_add_u32 s41, s39, s59
    buffer_load_dwordx4 v[192:195], v7, s[16:19], s41 offen offset:0 sc1
    buffer_load_dwordx4 v[196:199], v7, s[16:19], s41 offen offset:1024 sc1
    buffer_load_dwordx4 v[200:203], v7, s[16:19], s41 offen offset:2048 sc1
    buffer_load_dwordx4 v[204:207], v7, s[16:19], s41 offen offset:3072 sc1
Lpoll0c:
    v_mfma_f32_32x32x16_bf16 v[128:143], v[120:123], v[120:123], 0
    v_mfma_f32_32x32x16_bf16 v[144:159], v[120:123], v[120:123], 0
    v_mfma_f32_32x32x16_bf16 v[160:175], v[120:123], v[120:123], 0
    v_mfma_f32_32x32x16_bf16 v[176:191], v[120:123], v[120:123], 0
    s_branch Lattn
Lcomp:
Lstop5:
    s_cbranch_execz Lstop15
    s_lshl_b32 s43, s29, 12
    s_setprio 1
    v_and_b32 v3, 31, v2
    v_lshrrev_b32 v4, 5, v2
    v_bfe_u32 v5, v2, 1, 3
    v_xor_b32 v5, v5, v4
    v_lshlrev_b32 v5, 4, v5
    v_lshl_add_u32 v5, v3, 7, v5
    v_add_u32 v8, s43, v5
    v_xor_b32 v9, 32, v8
    v_xor_b32 v10, 64, v8
    v_xor_b32 v11, 96, v8
    v_lshlrev_b32 v119, 4, v4
    v_lshl_add_u32 v119, v3, 5, v119
    v_add_u32 v119, 160256, v119
    v_lshrrev_b32 v4, 5, v2
    v_bfe_u32 v5, v2, 2, 2
    v_lshl_add_u32 v6, v4, 3, v5
    v_bfe_u32 v24, v2, 4, 1
    v_and_b32 v25, 3, v2
    v_lshl_add_u32 v24, v24, 2, v25
    v_add_u32 v25, 2, v24
    v_lshrrev_b32 v25, 3, v25
    v_xor_b32 v24, v24, v25
    v_lshlrev_b32 v25, 3, v24
    v_lshl_add_u32 v24, v6, 7, v25
    v_lshrrev_b32 v5, 1, v5
    v_lshl_add_u32 v24, v5, 6, v24
    v_add_u32 v12, 65536, v24
    v_xor_b32 v13, 64, v12
    s_lshl_b32 s35, s29, 8
    s_add_u32 s35, s35, 155648
    v_lshl_add_u32 v15, v2, 2, s35
    v_lshl_add_u32 v26, v4, 4, s35
    s_lshl_b32 s35, s29, 9
    s_add_u32 s35, s35, 157696
    v_lshl_add_u32 v14, v2, 3, s35
    s_waitcnt lgkmcnt(0)
    s_load_dword s33, s[84:85], 0
    s_mov_b32 s58, 50000
    s_mov_b32 s56, 0
    s_mov_b32 s57, 0x3f803f80
    v_lshlrev_b32 v7, 4, v2
    s_cmp_ge_u32 s63, 8
    s_cbranch_scc1 LcompV
    v_bfe_u32 v3, v2, 2, 1
    v_bfe_u32 v4, v2, 3, 1
    v_and_b32 v5, 0x33, v2
    v_lshl_add_u32 v5, v3, 3, v5
    v_lshl_add_u32 v5, v4, 2, v5
    v_lshlrev_b32 v27, 4, v5
    v_lshrrev_b32 v111, 4, v2
    v_bfe_u32 v108, v2, 2, 2
    v_and_b32 v1, 3, v2
    v_mul_u32_u24 v105, 896, v111
    v_lshl_add_u32 v105, v1, 3, v105
    v_and_b32 v1, 1, v111
    v_lshl_add_u32 v105, v1, 6, v105
    v_lshrrev_b32 v1, 1, v108
    v_lshl_add_u32 v105, v1, 5, v105
    v_add_u32 v105, 98304, v105
    v_lshl_add_u32 v96, v108, 7, v105
    v_min_u32 v108, 2, v108
    v_lshl_add_u32 v100, v108, 7, v105
    v_xor_b32 v97, 32, v96
    v_xor_b32 v101, 32, v100
    v_xor_b32 v98, 64, v96
    v_xor_b32 v102, 64, v100
    v_xor_b32 v99, 96, v96
    v_xor_b32 v103, 96, v100
    s_lshl_b32 s36, s29, 12
    s_add_u32 s35, s36, 32768
    v_add_u32 v104, s35, v7
    s_add_u32 s35, s36, 49152
    v_and_b32 v109, 15, v2
    v_mul_u32_u24 v106, 144, v109
    v_lshl_add_u32 v106, v111, 3, v106
    v_add_u32 v106, s35, v106
    v_lshrrev_b32 v1, 3, v2
    v_lshl_add_u32 v1, v1, 4, v7
    v_add_u32 v105, s35, v1
    v_lshlrev_b32 v110, 4, v111
    v_add_u32 v1, 1, v111
    v_lshrrev_b32 v1, 2, v1
    v_lshl_add_u32 v107, v1, 30, v7
    v_lshlrev_b32 v1, 4, v109
    v_add_u32 v111, 156928, v1
    s_lshl_b32 s35, s29, 4
    v_add_u32 v109, s35, v109
    v_lshlrev_b32 v108, 2, v109
    v_add_u32 v108, 156928, v108
    v_mov_b32 v16, 0
    v_mov_b32 v17, 0
    v_mov_b32 v18, 0
    v_mov_b32 v19, 0
    v_mov_b32 v28, 0
    v_mov_b32 v29, 0
    v_mov_b32 v30, 0
    v_mov_b32 v31, 0
    v_mfma_f32_32x32x16_bf16 v[128:143], v[16:19], v[16:19], 0
    v_mfma_f32_32x32x16_bf16 v[144:159], v[16:19], v[16:19], 0
    v_mfma_f32_32x32x16_bf16 v[160:175], v[16:19], v[16:19], 0
    v_mfma_f32_32x32x16_bf16 v[176:191], v[16:19], v[16:19], 0
    s_waitcnt lgkmcnt(0)
    s_barrier
    ds_read_b128 v[192:195], v8 offset:0
    ds_read_b128 v[196:199], v9 offset:0
    ds_read_b128 v[200:203], v10 offset:0
    ds_read_b128 v[204:207], v11 offset:0
    ds_read_b64_tr_b16 v[64:65], v12 offset:0
    ds_read_b64_tr_b16 v[66:67], v12 offset:512
    ds_read_b64_tr_b16 v[72:73], v12 offset:2048
    ds_read_b64_tr_b16 v[74:75], v12 offset:2560
    s_waitcnt lgkmcnt(7)
    v_dot2c_f32_bf16 v16, s57, v192
    v_dot2c_f32_bf16 v28, v192, v192
    ds_read_b64_tr_b16 v[80:81], v12 offset:4096
    v_dot2c_f32_bf16 v17, s57, v193
    v_dot2c_f32_bf16 v29, v193, v193
    ds_read_b64_tr_b16 v[82:83], v12 offset:4608
    v_dot2c_f32_bf16 v18, s57, v194
    v_dot2c_f32_bf16 v30, v194, v194
    ds_read_b64_tr_b16 v[88:89], v12 offset:6144
    v_dot2c_f32_bf16 v19, s57, v195
    v_dot2c_f32_bf16 v31, v195, v195
    ds_read_b64_tr_b16 v[90:91], v12 offset:6656
    s_waitcnt lgkmcnt(10)
    v_dot2c_f32_bf16 v16, s57, v196
    v_dot2c_f32_bf16 v28, v196, v196
    ds_read_b64_tr_b16 v[68:69], v13 offset:0
    v_dot2c_f32_bf16 v17, s57, v197
    v_dot2c_f32_bf16 v29, v197, v197
    ds_read_b64_tr_b16 v[70:71], v13 offset:512
    v_dot2c_f32_bf16 v18, s57, v198
    v_dot2c_f32_bf16 v30, v198, v198
    ds_read_b64_tr_b16 v[76:77], v13 offset:2048
    v_dot2c_f32_bf16 v19, s57, v199
    v_dot2c_f32_bf16 v31, v199, v199
    ds_read_b64_tr_b16 v[78:79], v13 offset:2560
    s_waitcnt lgkmcnt(13)
    v_dot2c_f32_bf16 v16, s57, v200
    v_dot2c_f32_bf16 v28, v200, v200
    ds_read_b64_tr_b16 v[84:85], v13 offset:4096
    v_dot2c_f32_bf16 v17, s57, v201
    v_dot2c_f32_bf16 v29, v201, v201
    ds_read_b64_tr_b16 v[86:87], v13 offset:4608
    v_dot2c_f32_bf16 v18, s57, v202
    v_dot2c_f32_bf16 v30, v202, v202
    v_dot2c_f32_bf16 v19, s57, v203
    v_dot2c_f32_bf16 v31, v203, v203
    s_waitcnt lgkmcnt(14)
    v_dot2c_f32_bf16 v16, s57, v204
    v_dot2c_f32_bf16 v28, v204, v204
    ds_read_b64_tr_b16 v[92:93], v13 offset:6144
    v_dot2c_f32_bf16 v17, s57, v205
    v_dot2c_f32_bf16 v29, v205, v205
    v_dot2c_f32_bf16 v18, s57, v206
    v_dot2c_f32_bf16 v30, v206, v206
    v_dot2c_f32_bf16 v19, s57, v207
    v_dot2c_f32_bf16 v31, v207, v207
    s_waitcnt lgkmcnt(9)
    ds_read_b64_tr_b16 v[94:95], v13 offset:6656
    v_mfma_f32_32x32x16_bf16 v[32:47], v[64:67], v[192:195], 0
    s_mov_b32 s8, s64
    s_mov_b32 s9, s65
    s_mov_b32 s10, 1835008
    s_mov_b32 s11, 0x00020000
    s_mov_b32 s16, s84
    s_mov_b32 s17, s85
    s_mov_b32 s18, 16777216
    v_mfma_f32_32x32x16_bf16 v[32:47], v[72:75], v[196:199], v[32:47]
    s_mov_b32 s19, 0x00020000
    s_mul_i32 s33, s33, 0x9e3779b1
    s_add_u32 s33, s33, 0x7f4a7c15
    s_mul_i32 s35, s51, 37
    s_lshr_b32 s35, s35, 8
    s_mul_i32 s36, s35, 7
    s_sub_u32 s54, s51, s36
    v_mfma_f32_32x32x16_bf16 v[32:47], v[80:83], v[200:203], v[32:47]
    s_lshl_b32 s36, s52, 2
    s_add_u32 s55, s36, s54
    s_min_u32 s35, s35, 3
    s_add_u32 s53, s36, s35
    s_lshl_b32 s35, s32, 3
    s_add_u32 s35, s35, s29
    s_lshl_b32 s36, s35, 12
    s_waitcnt lgkmcnt(8)
    v_mfma_f32_32x32x16_bf16 v[32:47], v[88:91], v[204:207], v[32:47]
    s_add_u32 s39, s36, 1064960
    s_lshl_b32 s35, s32, 6
    s_add_u32 s35, s35, s29
    s_lshl_b32 s36, s31, 2
    s_add_u32 s35, s35, s36
    s_lshl_b32 s36, s35, 11
    s_add_u32 s3, s36, 6292480
    s_waitcnt lgkmcnt(0)
    s_barrier
    v_mfma_f32_32x32x16_bf16 v[48:63], v[68:71], v[192:195], 0
    ds_read_b128 v[208:211], v8 offset:16384
    ds_read_b128 v[212:215], v9 offset:16384
    ds_read_b128 v[216:219], v10 offset:16384
    ds_read_b128 v[220:223], v11 offset:16384
    v_mfma_f32_32x32x16_bf16 v[48:63], v[76:79], v[196:199], v[48:63]
    ds_read_b64_tr_b16 v[224:225], v12 offset:8192
    ds_read_b64_tr_b16 v[226:227], v12 offset:8704
    ds_read_b64_tr_b16 v[232:233], v12 offset:10240
    ds_read_b64_tr_b16 v[234:235], v12 offset:10752
    v_mfma_f32_32x32x16_bf16 v[48:63], v[84:87], v[200:203], v[48:63]
    ds_read_b64_tr_b16 v[240:241], v12 offset:12288
    ds_read_b64_tr_b16 v[242:243], v12 offset:12800
    ds_read_b64_tr_b16 v[248:249], v12 offset:14336
Lstop6:
    s_cbranch_execz Ltour_ret
    ds_read_b64_tr_b16 v[250:251], v12 offset:14848
    v_mfma_f32_32x32x16_bf16 v[48:63], v[92:95], v[204:207], v[48:63]
    ds_read_b64_tr_b16 v[228:229], v13 offset:8192
    ds_read_b64_tr_b16 v[230:231], v13 offset:8704
    ds_read_b64_tr_b16 v[236:237], v13 offset:10240
    s_waitcnt lgkmcnt(14)
    v_dot2c_f32_bf16 v16, s57, v208
    v_dot2c_f32_bf16 v28, v208, v208
    ds_read_b64_tr_b16 v[238:239], v13 offset:10752
    v_dot2c_f32_bf16 v17, s57, v209
    v_dot2c_f32_bf16 v29, v209, v209
    v_dot2c_f32_bf16 v18, s57, v210
    v_dot2c_f32_bf16 v30, v210, v210
    v_dot2c_f32_bf16 v19, s57, v211
    v_dot2c_f32_bf16 v31, v211, v211
    s_waitcnt lgkmcnt(14)
    v_dot2c_f32_bf16 v16, s57, v212
    v_dot2c_f32_bf16 v28, v212, v212
    ds_read_b64_tr_b16 v[244:245], v13 offset:12288
    v_dot2c_f32_bf16 v17, s57, v213
    v_dot2c_f32_bf16 v29, v213, v213
    v_dot2c_f32_bf16 v18, s57, v214
    v_dot2c_f32_bf16 v30, v214, v214
    v_dot2c_f32_bf16 v19, s57, v215
    v_dot2c_f32_bf16 v31, v215, v215
    s_waitcnt lgkmcnt(14)
    v_dot2c_f32_bf16 v16, s57, v216
    v_dot2c_f32_bf16 v28, v216, v216
    ds_read_b64_tr_b16 v[246:247], v13 offset:12800
    v_dot2c_f32_bf16 v17, s57, v217
    v_dot2c_f32_bf16 v29, v217, v217
    v_dot2c_f32_bf16 v18, s57, v218
    v_dot2c_f32_bf16 v30, v218, v218
    v_dot2c_f32_bf16 v19, s57, v219
    v_dot2c_f32_bf16 v31, v219, v219
    s_waitcnt lgkmcnt(14)
    v_dot2c_f32_bf16 v16, s57, v220
    v_dot2c_f32_bf16 v28, v220, v220
    ds_read_b64_tr_b16 v[252:253], v13 offset:14336
    v_dot2c_f32_bf16 v17, s57, v221
    v_dot2c_f32_bf16 v29, v221, v221
    v_dot2c_f32_bf16 v18, s57, v222
    v_dot2c_f32_bf16 v30, v222, v222
    v_dot2c_f32_bf16 v19, s57, v223
    v_dot2c_f32_bf16 v31, v223, v223
    s_waitcnt lgkmcnt(9)
    ds_read_b64_tr_b16 v[254:255], v13 offset:14848
    v_mfma_f32_32x32x16_bf16 v[32:47], v[224:227], v[208:211], v[32:47]
    s_lshl_b32 s36, s35, 8
    s_add_u32 s4, s36, 786560
    s_lshl_b32 s36, s53, 1
    s_lshr_b32 s35, s29, 1
    s_add_u32 s35, s35, s36
    s_lshl_b32 s35, s35, 8
    s_lshr_b32 s36, s52, 2
    v_mfma_f32_32x32x16_bf16 v[32:47], v[232:235], v[212:215], v[32:47]
    s_xor_b32 s36, s36, 0
    s_lshl_b32 s36, s36, 17
    s_add_u32 s35, s35, s36
    s_add_u32 s5, s35, 786432
    v_bfe_u32 v1, v2, 1, 3
    v_and_b32 v4, 1, v2
    v_lshlrev_b32 v1, 14, v1
    v_mfma_f32_32x32x16_bf16 v[32:47], v[240:243], v[216:219], v[32:47]
    v_lshl_add_u32 v115, v4, 7, v1
    s_mul_i32 s35, s28, 12288
    v_add_u32 v113, s35, v7
    v_mov_b32 v120, 0
    v_mov_b32 v121, 0
    v_mov_b32 v122, 0
    v_mov_b32 v123, 0
    s_waitcnt lgkmcnt(8)
    v_mfma_f32_32x32x16_bf16 v[32:47], v[248:251], v[220:223], v[32:47]
    s_lshl_b32 s35, s52, 2
    s_add_u32 s35, s35, s29
    s_lshl_b32 s35, s35, 8
    s_add_u32 s38, s35, 12288
    s_mul_i32 s35, s31, 43
    s_lshr_b32 s35, s35, 8
    s_mul_i32 s35, s35, 6
    s_waitcnt lgkmcnt(0)
    s_barrier
    v_mfma_f32_32x32x16_bf16 v[48:63], v[228:231], v[208:211], v[48:63]
    ds_read_b128 v[192:195], v8 offset:32768
    ds_read_b128 v[196:199], v9 offset:32768
    ds_read_b128 v[200:203], v10 offset:32768
    ds_read_b128 v[204:207], v11 offset:32768
    v_mfma_f32_32x32x16_bf16 v[48:63], v[236:239], v[212:215], v[48:63]
    ds_read_b64_tr_b16 v[64:65], v12 offset:16384
    ds_read_b64_tr_b16 v[66:67], v12 offset:16896
    ds_read_b64_tr_b16 v[72:73], v12 offset:18432
    ds_read_b64_tr_b16 v[74:75], v12 offset:18944
    v_mfma_f32_32x32x16_bf16 v[48:63], v[244:247], v[216:219], v[48:63]
    ds_read_b64_tr_b16 v[80:81], v12 offset:20480
    ds_read_b64_tr_b16 v[82:83], v12 offset:20992
    ds_read_b64_tr_b16 v[88:89], v12 offset:22528
    ds_read_b64_tr_b16 v[90:91], v12 offset:23040
    v_mfma_f32_32x32x16_bf16 v[48:63], v[252:255], v[220:223], v[48:63]
    ds_read_b64_tr_b16 v[68:69], v13 offset:16384
    ds_read_b64_tr_b16 v[70:71], v13 offset:16896
    ds_read_b64_tr_b16 v[76:77], v13 offset:18432
    s_waitcnt lgkmcnt(14)
    v_dot2c_f32_bf16 v16, s57, v192
    v_dot2c_f32_bf16 v28, v192, v192
    ds_read_b64_tr_b16 v[78:79], v13 offset:18944
    v_dot2c_f32_bf16 v17, s57, v193
    v_dot2c_f32_bf16 v29, v193, v193
    v_dot2c_f32_bf16 v18, s57, v194
    v_dot2c_f32_bf16 v30, v194, v194
    v_dot2c_f32_bf16 v19, s57, v195
    v_dot2c_f32_bf16 v31, v195, v195
    s_waitcnt lgkmcnt(14)
    v_dot2c_f32_bf16 v16, s57, v196
    v_dot2c_f32_bf16 v28, v196, v196
    ds_read_b64_tr_b16 v[84:85], v13 offset:20480
    v_dot2c_f32_bf16 v17, s57, v197
    v_dot2c_f32_bf16 v29, v197, v197
    v_dot2c_f32_bf16 v18, s57, v198
    v_dot2c_f32_bf16 v30, v198, v198
    v_dot2c_f32_bf16 v19, s57, v199
    v_dot2c_f32_bf16 v31, v199, v199
    s_waitcnt lgkmcnt(14)
    v_dot2c_f32_bf16 v16, s57, v200
    v_dot2c_f32_bf16 v28, v200, v200
    ds_read_b64_tr_b16 v[86:87], v13 offset:20992
    v_dot2c_f32_bf16 v17, s57, v201
    v_dot2c_f32_bf16 v29, v201, v201
    v_dot2c_f32_bf16 v18, s57, v202
    v_dot2c_f32_bf16 v30, v202, v202
    v_dot2c_f32_bf16 v19, s57, v203
    v_dot2c_f32_bf16 v31, v203, v203
    s_waitcnt lgkmcnt(14)
    v_dot2c_f32_bf16 v16, s57, v204
    v_dot2c_f32_bf16 v28, v204, v204
    ds_read_b64_tr_b16 v[92:93], v13 offset:22528
    v_dot2c_f32_bf16 v17, s57, v205
    v_dot2c_f32_bf16 v29, v205, v205
    v_dot2c_f32_bf16 v18, s57, v206
    v_dot2c_f32_bf16 v30, v206, v206
    v_dot2c_f32_bf16 v19, s57, v207
    v_dot2c_f32_bf16 v31, v207, v207
    s_waitcnt lgkmcnt(9)
    ds_read_b64_tr_b16 v[94:95], v13 offset:23040
    v_mfma_f32_32x32x16_bf16 v[32:47], v[64:67], v[192:195], v[32:47]
    s_sub_u32 s40, s31, s35
    s_lshl_b32 s35, s53, 2
    s_add_u32 s35, s35, s29
    s_lshl_b32 s36, s35, 4
    v_lshrrev_b32 v1, 3, v2
    v_mul_u32_u24 v112, 896, v1
    s_mulk_i32 s36, 896
    v_mfma_f32_32x32x16_bf16 v[32:47], v[72:75], v[196:199], v[32:47]
    v_and_b32 v4, 0x70, v7
    v_add3_u32 v127, v112, v4, s36
    s_and_b32 s36, s29, 1
    s_lshl_b32 s37, s36, 6
    v_xor_b32 v4, s37, v4
    v_and_b32 v1, 16, v2
    v_lshlrev_b32 v1, 1, v1
    v_mfma_f32_32x32x16_bf16 v[32:47], v[80:83], v[200:203], v[32:47]
    v_xor_b32 v4, v1, v4
    v_add_u32 v112, v112, v4
    s_lshl_b32 s36, s36, 8
    v_and_b32 v1, 0xf0, v7
    v_and_b32 v4, 0x300, v7
    v_lshl_add_u32 v1, v4, 1, v1
    v_add_u32 v124, s36, v1
    s_waitcnt lgkmcnt(8)
    v_mfma_f32_32x32x16_bf16 v[32:47], v[88:91], v[204:207], v[32:47]
    s_lshl_b32 s71, s54, 7
    s_mul_i32 s36, s28, 6272
    s_mul_i32 s70, s28, 896
    s_mov_b32 s20, s68
    s_mov_b32 s21, s69
    s_mov_b32 s22, 401408
    s_mov_b32 s23, 0x00020000
    s_waitcnt lgkmcnt(0)
    s_barrier
    v_mfma_f32_32x32x16_bf16 v[48:63], v[68:71], v[192:195], v[48:63]
    ds_read_b128 v[208:211], v8 offset:49152
    ds_read_b128 v[212:215], v9 offset:49152
    ds_read_b128 v[216:219], v10 offset:49152
    ds_read_b128 v[220:223], v11 offset:49152
    v_mfma_f32_32x32x16_bf16 v[48:63], v[76:79], v[196:199], v[48:63]
    ds_read_b64_tr_b16 v[224:225], v12 offset:24576
    ds_read_b64_tr_b16 v[226:227], v12 offset:25088
    ds_read_b64_tr_b16 v[232:233], v12 offset:26624
    ds_read_b64_tr_b16 v[234:235], v12 offset:27136
    v_mfma_f32_32x32x16_bf16 v[48:63], v[84:87], v[200:203], v[48:63]
    ds_read_b64_tr_b16 v[240:241], v12 offset:28672
    ds_read_b64_tr_b16 v[242:243], v12 offset:29184
    ds_read_b64_tr_b16 v[248:249], v12 offset:30720
    ds_read_b64_tr_b16 v[250:251], v12 offset:31232
    v_mfma_f32_32x32x16_bf16 v[48:63], v[92:95], v[204:207], v[48:63]
    ds_read_b64_tr_b16 v[228:229], v13 offset:24576
    ds_read_b64_tr_b16 v[230:231], v13 offset:25088
    ds_read_b64_tr_b16 v[236:237], v13 offset:26624
    s_waitcnt lgkmcnt(14)
    v_dot2c_f32_bf16 v16, s57, v208
    v_dot2c_f32_bf16 v28, v208, v208
    ds_read_b64_tr_b16 v[238:239], v13 offset:27136
    v_dot2c_f32_bf16 v17, s57, v209
    v_dot2c_f32_bf16 v29, v209, v209
    v_dot2c_f32_bf16 v18, s57, v210
    v_dot2c_f32_bf16 v30, v210, v210
    v_dot2c_f32_bf16 v19, s57, v211
    v_dot2c_f32_bf16 v31, v211, v211
    s_waitcnt lgkmcnt(14)
    v_dot2c_f32_bf16 v16, s57, v212
    v_dot2c_f32_bf16 v28, v212, v212
    ds_read_b64_tr_b16 v[244:245], v13 offset:28672
    v_dot2c_f32_bf16 v17, s57, v213
    v_dot2c_f32_bf16 v29, v213, v213
    v_dot2c_f32_bf16 v18, s57, v214
    v_dot2c_f32_bf16 v30, v214, v214
    v_dot2c_f32_bf16 v19, s57, v215
    v_dot2c_f32_bf16 v31, v215, v215
    s_waitcnt lgkmcnt(14)
    v_dot2c_f32_bf16 v16, s57, v216
    v_dot2c_f32_bf16 v28, v216, v216
    ds_read_b64_tr_b16 v[246:247], v13 offset:29184
    v_dot2c_f32_bf16 v17, s57, v217
    v_dot2c_f32_bf16 v29, v217, v217
Lstop7:
    s_cbranch_execz Ltour_ret
    v_dot2c_f32_bf16 v18, s57, v218
    v_dot2c_f32_bf16 v30, v218, v218
    v_dot2c_f32_bf16 v19, s57, v219
    v_dot2c_f32_bf16 v31, v219, v219
    s_waitcnt lgkmcnt(14)
    v_dot2c_f32_bf16 v16, s57, v220
    v_dot2c_f32_bf16 v28, v220, v220
    ds_read_b64_tr_b16 v[252:253], v13 offset:30720
    v_dot2c_f32_bf16 v17, s57, v221
    v_dot2c_f32_bf16 v29, v221, v221
    v_dot2c_f32_bf16 v18, s57, v222
    v_dot2c_f32_bf16 v30, v222, v222
    v_dot2c_f32_bf16 v19, s57, v223
    v_dot2c_f32_bf16 v31, v223, v223
    s_waitcnt lgkmcnt(9)
    ds_read_b64_tr_b16 v[254:255], v13 offset:31232
    v_mfma_f32_32x32x16_bf16 v[32:47], v[224:227], v[208:211], v[32:47]
    s_lshl_b32 s37, s51, 3
    s_add_u32 s37, s37, s28
    s_mulk_i32 s37, 1664
    v_min_u32 v1, 12, v2
    v_lshl_add_u32 v117, v1, 7, s37
    s_add_u32 s71, s71, s36
    s_lshr_b32 s35, s51, 3
    v_mfma_f32_32x32x16_bf16 v[32:47], v[232:235], v[212:215], v[32:47]
    s_lshl_b32 s36, s52, 2
    s_add_u32 s35, s35, s36
    s_min_u32 s35, s35, 27
    s_cmp_eq_u32 s29, 1
    s_cselect_b64 s[24:25], s[74:75], s[76:77]
    s_add_u32 s36, s29, 1
    s_bitcmp0_b32 s36, 1
    v_mfma_f32_32x32x16_bf16 v[32:47], v[240:243], v[216:219], v[32:47]
    s_cselect_b64 s[24:25], s[78:79], s[24:25]
    s_mov_b32 s26, 1605632
    s_mov_b32 s27, 0x00020000
    s_movk_i32 s36, 128
    s_cselect_b32 s37, s36, 3584
    s_cselect_b32 s36, 57344, s36
    s_mul_i32 s36, s35, s36
    s_waitcnt lgkmcnt(8)
    v_mfma_f32_32x32x16_bf16 v[32:47], v[248:251], v[220:223], v[32:47]
    s_and_b32 s35, s51, 7
    s_mul_i32 s35, s35, 56
    s_mul_i32 s35, s35, s37
    s_add_u32 s36, s36, s35
    v_min_u32 v1, 55, v2
    v_mul_u32_u24 v1, s37, v1
    v_add_u32 v114, s36, v1
    s_waitcnt lgkmcnt(0)
    s_barrier
    v_mfma_f32_32x32x16_bf16 v[48:63], v[228:231], v[208:211], v[48:63]
    ds_read_b128 v[192:195], v8 offset:0
    ds_read_b128 v[196:199], v9 offset:0
Lstop8:
    s_cbranch_execz Lstop16
    ds_read_b128 v[200:203], v10 offset:0
    ds_read_b128 v[204:207], v11 offset:0
    v_mfma_f32_32x32x16_bf16 v[48:63], v[236:239], v[212:215], v[48:63]
    ds_read_b64_tr_b16 v[64:65], v12 offset:0
    ds_read_b64_tr_b16 v[66:67], v12 offset:512
    ds_read_b64_tr_b16 v[72:73], v12 offset:2048
    ds_read_b64_tr_b16 v[74:75], v12 offset:2560
    v_mfma_f32_32x32x16_bf16 v[48:63], v[244:247], v[216:219], v[48:63]
    ds_read_b64_tr_b16 v[80:81], v12 offset:4096
    ds_read_b64_tr_b16 v[82:83], v12 offset:4608
    ds_read_b64_tr_b16 v[88:89], v12 offset:6144
    ds_read_b64_tr_b16 v[90:91], v12 offset:6656
    v_mfma_f32_32x32x16_bf16 v[48:63], v[252:255], v[220:223], v[48:63]
    ds_read_b64_tr_b16 v[68:69], v13 offset:0
    ds_read_b64_tr_b16 v[70:71], v13 offset:512
    ds_read_b64_tr_b16 v[76:77], v13 offset:2048
    s_waitcnt lgkmcnt(14)
    v_dot2c_f32_bf16 v16, s57, v192
    v_dot2c_f32_bf16 v28, v192, v192
    ds_read_b64_tr_b16 v[78:79], v13 offset:2560
    v_dot2c_f32_bf16 v17, s57, v193
    v_dot2c_f32_bf16 v29, v193, v193
    v_dot2c_f32_bf16 v18, s57, v194
    v_dot2c_f32_bf16 v30, v194, v194
    v_dot2c_f32_bf16 v19, s57, v195
    v_dot2c_f32_bf16 v31, v195, v195
    s_waitcnt lgkmcnt(14)
    v_dot2c_f32_bf16 v16, s57, v196
    v_dot2c_f32_bf16 v28, v196, v196
    ds_read_b64_tr_b16 v[84:85], v13 offset:4096
    v_dot2c_f32_bf16 v17, s57, v197
    v_dot2c_f32_bf16 v29, v197, v197
    v_dot2c_f32_bf16 v18, s57, v198
    v_dot2c_f32_bf16 v30, v198, v198
    v_dot2c_f32_bf16 v19, s57, v199
    v_dot2c_f32_bf16 v31, v199, v199
    s_waitcnt lgkmcnt(14)
    v_dot2c_f32_bf16 v16, s57, v200
    v_dot2c_f32_bf16 v28, v200, v200
    ds_read_b64_tr_b16 v[86:87], v13 offset:4608
    v_dot2c_f32_bf16 v17, s57, v201
    v_dot2c_f32_bf16 v29, v201, v201
    v_dot2c_f32_bf16 v18, s57, v202
    v_dot2c_f32_bf16 v30, v202, v202
    v_dot2c_f32_bf16 v19, s57, v203
    v_dot2c_f32_bf16 v31, v203, v203
    s_waitcnt lgkmcnt(14)
    v_dot2c_f32_bf16 v16, s57, v204
    v_dot2c_f32_bf16 v28, v204, v204
    ds_read_b64_tr_b16 v[92:93], v13 offset:6144
    v_dot2c_f32_bf16 v17, s57, v205
    v_dot2c_f32_bf16 v29, v205, v205
    v_dot2c_f32_bf16 v18, s57, v206
    v_dot2c_f32_bf16 v30, v206, v206
    v_dot2c_f32_bf16 v19, s57, v207
    v_dot2c_f32_bf16 v31, v207, v207
    s_waitcnt lgkmcnt(9)
    ds_read_b64_tr_b16 v[94:95], v13 offset:6656
    v_mfma_f32_32x32x16_bf16 v[32:47], v[64:67], v[192:195], v[32:47]
    s_and_b32 s35, s31, 7
    s_lshl_b32 s35, s35, 3
    s_add_u32 s35, s35, s52
    s_lshl_b32 s35, s35, 2
    s_lshr_b32 s36, s31, 3
    s_add_u32 s35, s35, s36
    s_lshl_b32 s35, s35, 2
    v_mfma_f32_32x32x16_bf16 v[32:47], v[72:75], v[196:199], v[32:47]
    s_add_u32 s35, s35, s29
    s_lshl_b32 s35, s35, 12
    s_lshr_b32 s36, s63, 3
    s_lshl_b32 s36, s36, 11
    s_add_u32 s35, s35, s36
    s_add_u32 s46, s35, 1048576
    s_add_u32 s47, s46, 32768
    v_mfma_f32_32x32x16_bf16 v[32:47], v[80:83], v[200:203], v[32:47]
    s_lshl_b32 s35, s52, 2
    s_add_u32 s35, s35, s29
    s_lshl_b32 s35, s35, 8
    s_lshl_b32 s36, s51, 2
    s_add_u32 s35, s35, s36
    s_add_u32 s61, s35, 12288
    s_lshl_b32 s35, s29, 2
    s_waitcnt lgkmcnt(8)
    v_mfma_f32_32x32x16_bf16 v[32:47], v[88:91], v[204:207], v[32:47]
    s_add_u32 s35, s35, 157248
    v_mov_b32 v118, s35
    s_sub_u32 s35, s5, 786432
    s_lshl_b32 s35, s35, 3
    s_add_u32 s35, s35, 6291456
    s_mov_b32 s36, 0
    s_lshl_b32 s37, s36, 19
    s_waitcnt lgkmcnt(0)
    s_barrier
    v_mfma_f32_32x32x16_bf16 v[48:63], v[68:71], v[192:195], v[48:63]
    ds_read_b128 v[208:211], v8 offset:16384
    ds_read_b128 v[212:215], v9 offset:16384
    ds_read_b128 v[216:219], v10 offset:16384
    ds_read_b128 v[220:223], v11 offset:16384
    v_mfma_f32_32x32x16_bf16 v[48:63], v[76:79], v[196:199], v[48:63]
    ds_read_b64_tr_b16 v[224:225], v12 offset:8192
    ds_read_b64_tr_b16 v[226:227], v12 offset:8704
    ds_read_b64_tr_b16 v[232:233], v12 offset:10240
    ds_read_b64_tr_b16 v[234:235], v12 offset:10752
    v_mfma_f32_32x32x16_bf16 v[48:63], v[84:87], v[200:203], v[48:63]
    ds_read_b64_tr_b16 v[240:241], v12 offset:12288
    ds_read_b64_tr_b16 v[242:243], v12 offset:12800
    ds_read_b64_tr_b16 v[248:249], v12 offset:14336
    ds_read_b64_tr_b16 v[250:251], v12 offset:14848
    v_mfma_f32_32x32x16_bf16 v[48:63], v[92:95], v[204:207], v[48:63]
    ds_read_b64_tr_b16 v[228:229], v13 offset:8192
    ds_read_b64_tr_b16 v[230:231], v13 offset:8704
    ds_read_b64_tr_b16 v[236:237], v13 offset:10240
    s_waitcnt lgkmcnt(14)
    v_dot2c_f32_bf16 v16, s57, v208
    v_dot2c_f32_bf16 v28, v208, v208
    ds_read_b64_tr_b16 v[238:239], v13 offset:10752
    v_dot2c_f32_bf16 v17, s57, v209
    v_dot2c_f32_bf16 v29, v209, v209
    v_dot2c_f32_bf16 v18, s57, v210
    v_dot2c_f32_bf16 v30, v210, v210
    v_dot2c_f32_bf16 v19, s57, v211
    v_dot2c_f32_bf16 v31, v211, v211
    s_waitcnt lgkmcnt(14)
    v_dot2c_f32_bf16 v16, s57, v212
    v_dot2c_f32_bf16 v28, v212, v212
    ds_read_b64_tr_b16 v[244:245], v13 offset:12288
    v_dot2c_f32_bf16 v17, s57, v213
    v_dot2c_f32_bf16 v29, v213, v213
    v_dot2c_f32_bf16 v18, s57, v214
    v_dot2c_f32_bf16 v30, v214, v214
    v_dot2c_f32_bf16 v19, s57, v215
    v_dot2c_f32_bf16 v31, v215, v215
    s_waitcnt lgkmcnt(14)
    v_dot2c_f32_bf16 v16, s57, v216
    v_dot2c_f32_bf16 v28, v216, v216
    ds_read_b64_tr_b16 v[246:247], v13 offset:12800
    v_dot2c_f32_bf16 v17, s57, v217
    v_dot2c_f32_bf16 v29, v217, v217
    v_dot2c_f32_bf16 v18, s57, v218
    v_dot2c_f32_bf16 v30, v218, v218
    v_dot2c_f32_bf16 v19, s57, v219
    v_dot2c_f32_bf16 v31, v219, v219
    s_waitcnt lgkmcnt(14)
    v_dot2c_f32_bf16 v16, s57, v220
    v_dot2c_f32_bf16 v28, v220, v220
    ds_read_b64_tr_b16 v[252:253], v13 offset:14336
    v_dot2c_f32_bf16 v17, s57, v221
    v_dot2c_f32_bf16 v29, v221, v221
    v_dot2c_f32_bf16 v18, s57, v222
    v_dot2c_f32_bf16 v30, v222, v222
    v_dot2c_f32_bf16 v19, s57, v223
    v_dot2c_f32_bf16 v31, v223, v223
    s_waitcnt lgkmcnt(9)
    ds_read_b64_tr_b16 v[254:255], v13 offset:14848
    v_mfma_f32_32x32x16_bf16 v[32:47], v[224:227], v[208:211], v[32:47]
    s_sub_u32 s34, s35, s37
    s_add_u32 s6, s35, s37
    s_mul_i32 s35, s36, 14336
    s_lshl_b32 s48, s35, 1
    s_bfe_u32 s36, s5, 0x10011
    s_mulk_i32 s36, 28672
    s_add_u32 s35, s35, s36
    v_mfma_f32_32x32x16_bf16 v[32:47], v[232:235], v[212:215], v[32:47]
    v_add_u32 v96, s35, v96
    v_add_u32 v97, s35, v97
    v_add_u32 v98, s35, v98
    v_add_u32 v99, s35, v99
    v_add_u32 v100, s35, v100
    v_add_u32 v101, s35, v101
    v_add_u32 v102, s35, v102
    v_mfma_f32_32x32x16_bf16 v[32:47], v[240:243], v[216:219], v[32:47]
    v_add_u32 v103, s35, v103
    s_lshl_b32 s36, s53, 6
    v_add_u32 v109, s36, v109
    s_lshl_b32 s35, s29, 4
    s_add_u32 s35, s35, s36
    s_lshl_b32 s35, s35, 7
    s_add_u32 s49, s35, 524288
    s_waitcnt lgkmcnt(8)
    v_mfma_f32_32x32x16_bf16 v[32:47], v[248:251], v[220:223], v[32:47]
    s_lshl_b32 s35, s54, 8
    s_lshl_b32 s36, s36, 7
    s_add_u32 s35, s35, s36
    s_add_u32 s50, s35, 262144
    s_brev_b32 s82, 1
    s_movk_i32 s83, 0xf800
    s_waitcnt lgkmcnt(6)
    v_mfma_f32_32x32x16_bf16 v[48:63], v[228:231], v[208:211], v[48:63]
    s_waitcnt lgkmcnt(4)
    v_mfma_f32_32x32x16_bf16 v[48:63], v[236:239], v[212:215], v[48:63]
    s_waitcnt lgkmcnt(2)
    v_mfma_f32_32x32x16_bf16 v[48:63], v[244:247], v[216:219], v[48:63]
    s_waitcnt lgkmcnt(0)
    v_mfma_f32_32x32x16_bf16 v[48:63], v[252:255], v[220:223], v[48:63]
    s_waitcnt lgkmcnt(0)
    s_barrier
    ds_read_b128 v[192:195], v8 offset:32768
    ds_read_b128 v[196:199], v9 offset:32768
    ds_read_b128 v[200:203], v10 offset:32768
    ds_read_b128 v[204:207], v11 offset:32768
    ds_read_b64_tr_b16 v[64:65], v12 offset:16384
    ds_read_b64_tr_b16 v[66:67], v12 offset:16896
    ds_read_b64_tr_b16 v[72:73], v12 offset:18432
    ds_read_b64_tr_b16 v[74:75], v12 offset:18944
    s_waitcnt lgkmcnt(7)
    v_dot2c_f32_bf16 v16, s57, v192
    v_dot2c_f32_bf16 v28, v192, v192
    ds_read_b64_tr_b16 v[80:81], v12 offset:20480
    v_dot2c_f32_bf16 v17, s57, v193
    v_dot2c_f32_bf16 v29, v193, v193
    ds_read_b64_tr_b16 v[82:83], v12 offset:20992
    v_dot2c_f32_bf16 v18, s57, v194
    v_dot2c_f32_bf16 v30, v194, v194
    ds_read_b64_tr_b16 v[88:89], v12 offset:22528
    v_dot2c_f32_bf16 v19, s57, v195
    v_dot2c_f32_bf16 v31, v195, v195
    ds_read_b64_tr_b16 v[90:91], v12 offset:23040
    s_waitcnt lgkmcnt(10)
    v_dot2c_f32_bf16 v16, s57, v196
    v_dot2c_f32_bf16 v28, v196, v196
    ds_read_b64_tr_b16 v[68:69], v13 offset:16384
    v_dot2c_f32_bf16 v17, s57, v197
    v_dot2c_f32_bf16 v29, v197, v197
Lstop9:
    s_cbranch_execz Ltour_ret
    ds_read_b64_tr_b16 v[70:71], v13 offset:16896
    v_dot2c_f32_bf16 v18, s57, v198
    v_dot2c_f32_bf16 v30, v198, v198
    ds_read_b64_tr_b16 v[76:77], v13 offset:18432
    v_dot2c_f32_bf16 v19, s57, v199
    v_dot2c_f32_bf16 v31, v199, v199
    ds_read_b64_tr_b16 v[78:79], v13 offset:18944
    s_waitcnt lgkmcnt(13)
    v_dot2c_f32_bf16 v16, s57, v200
    v_dot2c_f32_bf16 v28, v200, v200
    ds_read_b64_tr_b16 v[84:85], v13 offset:20480
    v_dot2c_f32_bf16 v17, s57, v201
    v_dot2c_f32_bf16 v29, v201, v201
    ds_read_b64_tr_b16 v[86:87], v13 offset:20992
    v_dot2c_f32_bf16 v18, s57, v202
    v_dot2c_f32_bf16 v30, v202, v202
    v_dot2c_f32_bf16 v19, s57, v203
    v_dot2c_f32_bf16 v31, v203, v203
    s_waitcnt lgkmcnt(14)
    v_dot2c_f32_bf16 v16, s57, v204
    v_dot2c_f32_bf16 v28, v204, v204
    ds_read_b64_tr_b16 v[92:93], v13 offset:22528
    v_dot2c_f32_bf16 v17, s57, v205
    v_dot2c_f32_bf16 v29, v205, v205
    v_dot2c_f32_bf16 v18, s57, v206
    v_dot2c_f32_bf16 v30, v206, v206
    v_dot2c_f32_bf16 v19, s57, v207
    v_dot2c_f32_bf16 v31, v207, v207
    s_waitcnt lgkmcnt(9)
    ds_read_b64_tr_b16 v[94:95], v13 offset:23040
    v_mfma_f32_32x32x16_bf16 v[32:47], v[64:67], v[192:195], v[32:47]
    v_add_f32 v16, v16, v17
    v_add_f32 v18, v18, v19
    v_add_f32 v28, v28, v29
    v_add_f32 v30, v30, v31
    v_add_f32 v16, v16, v18
    v_add_f32 v17, v28, v30
    v_mfma_f32_32x32x16_bf16 v[32:47], v[72:75], v[196:199], v[32:47]
    v_mov_b32 v24, v16
    v_mov_b32 v25, v17
    s_nop 0
    v_permlane32_swap_b32 v24, v16
    v_permlane32_swap_b32 v25, v17
    v_add_f32 v16, v24, v16
    v_add_f32 v17, v25, v17
    v_mfma_f32_32x32x16_bf16 v[32:47], v[80:83], v[200:203], v[32:47]
    v_mul_f32 v16, 0x3b124925, v16
    v_mul_f32 v17, 0x3b124925, v17
    v_fma_f32 v17, -v16, v16, v17
    v_max_f32 v17, 0, v17
    v_cvt_pk_bf16_f32 v24, v17, -v16
    v_lshlrev_b32 v17, 16, v24
    s_waitcnt lgkmcnt(8)
    v_mfma_f32_32x32x16_bf16 v[32:47], v[88:91], v[204:207], v[32:47]
    s_waitcnt lgkmcnt(0)
    s_barrier
    ds_read_b128 v[224:227], v119
    ds_read_b128 v[228:231], v119 offset:1024
    ds_read_b32 v118, v118
    v_add_f32 v17, 0x3727c5ac, v17
    v_cvt_pk_bf16_f32 v17, v17, v17
    v_lshlrev_b32 v17, 16, v17
    v_sqrt_f32 v17, v17
    v_and_b32 v20, 0xffff0000, v24
    v_cvt_pk_bf16_f32 v17, v17, v17
    v_mfma_f32_32x32x16_bf16 v[48:63], v[68:71], v[192:195], v[48:63]
    v_lshlrev_b32 v17, 16, v17
    v_rcp_f32 v22, v17
    v_alignbit_b32 v28, v20, v20, 16
    v_or_b32 v28, v28, v20
    v_mov_b32 v29, v28
    v_mov_b32 v30, v28
    v_mfma_f32_32x32x16_bf16 v[48:63], v[76:79], v[196:199], v[48:63]
    v_mov_b32 v31, v28
    v_mfma_f32_32x32x16_bf16 v[48:63], v[84:87], v[200:203], v[48:63]
    v_mfma_f32_32x32x16_bf16 v[48:63], v[92:95], v[204:207], v[48:63]
    s_waitcnt lgkmcnt(0)
    v_mfma_f32_32x32x16_bf16 v[32:47], v[224:227], v[28:31], v[32:47]
    v_mfma_f32_32x32x16_bf16 v[48:63], v[228:231], v[28:31], v[48:63]
    v_readfirstlane_b32 s7, v118
    s_and_b32 s35, s31, 6
    s_cselect_b32 s43, 0, s7
    ds_write2_b32 v14, v28, v22 offset1:1
    s_nop 6
    v_mul_f32 v32, v32, v22
    v_mul_f32 v33, v33, v22
    v_cvt_pk_bf16_f32 v64, v32, v33
    v_mul_f32 v34, v34, v22
    v_mul_f32 v35, v35, v22
    v_cvt_pk_bf16_f32 v65, v34, v35
    v_mul_f32 v36, v36, v22
    v_mul_f32 v37, v37, v22
    v_cvt_pk_bf16_f32 v66, v36, v37
    v_mul_f32 v38, v38, v22
    v_mul_f32 v39, v39, v22
    v_cvt_pk_bf16_f32 v67, v38, v39
    v_mul_f32 v40, v40, v22
    v_mul_f32 v41, v41, v22
    v_cvt_pk_bf16_f32 v68, v40, v41
    v_mul_f32 v42, v42, v22
    v_mul_f32 v43, v43, v22
    v_cvt_pk_bf16_f32 v69, v42, v43
    v_mul_f32 v44, v44, v22
    v_mul_f32 v45, v45, v22
    v_cvt_pk_bf16_f32 v70, v44, v45
    v_mul_f32 v46, v46, v22
    v_mul_f32 v47, v47, v22
    v_cvt_pk_bf16_f32 v71, v46, v47
    s_mov_b32 exec_lo, 0
    v_mov_b32 v70, s57
    v_mov_b32 v71, 0x3f80
    s_mov_b32 exec_lo, -1
    s_cmp_eq_u32 s43, 0
    s_cbranch_scc1 Lglob_2
    buffer_store_dwordx4 v[64:67], v27, s[16:19], s46 offen
    buffer_store_dwordx4 v[68:71], v27, s[16:19], s46 offen offset:1024
    s_branch Ljoin_3
Lglob_2:
    buffer_store_dwordx4 v[64:67], v27, s[16:19], s46 offen sc1
    buffer_store_dwordx4 v[68:71], v27, s[16:19], s46 offen offset:1024 sc1
Ljoin_3:
    v_mul_f32 v48, v48, v22
    v_mul_f32 v49, v49, v22
    v_cvt_pk_bf16_f32 v72, v48, v49
    v_mul_f32 v50, v50, v22
    v_mul_f32 v51, v51, v22
    v_cvt_pk_bf16_f32 v73, v50, v51
    v_mul_f32 v52, v52, v22
    v_mul_f32 v53, v53, v22
    v_cvt_pk_bf16_f32 v74, v52, v53
    v_mul_f32 v54, v54, v22
    v_mul_f32 v55, v55, v22
    v_cvt_pk_bf16_f32 v75, v54, v55
    v_mul_f32 v56, v56, v22
    v_mul_f32 v57, v57, v22
    v_cvt_pk_bf16_f32 v76, v56, v57
    v_mul_f32 v58, v58, v22
    v_mul_f32 v59, v59, v22
    v_cvt_pk_bf16_f32 v77, v58, v59
    v_mul_f32 v60, v60, v22
    v_mul_f32 v61, v61, v22
    v_cvt_pk_bf16_f32 v78, v60, v61
    v_mul_f32 v62, v62, v22
    v_mul_f32 v63, v63, v22
    v_cvt_pk_bf16_f32 v79, v62, v63
    s_mov_b32 exec_lo, 0
    v_mov_b32 v78, s57
    v_mov_b32 v79, 0x3f80
    s_mov_b32 exec_lo, -1
    s_cmp_eq_u32 s43, 0
    s_cbranch_scc1 Lglob_4
    buffer_store_dwordx4 v[72:75], v27, s[16:19], s47 offen
    buffer_store_dwordx4 v[76:79], v27, s[16:19], s47 offen offset:1024
    s_branch Ljoin_5
Lglob_4:
    buffer_store_dwordx4 v[72:75], v27, s[16:19], s47 offen sc1
    buffer_store_dwordx4 v[76:79], v27, s[16:19], s47 offen offset:1024 sc1
Ljoin_5:
    s_branch LcompQ
LcompV:
Lstop10:
    s_cbranch_execz Lstop17
    v_and_b32 v3, 31, v2
    v_mul_u32_u24 v4, 37, v3
    v_lshrrev_b32 v4, 8, v4
    v_mul_u32_u24 v5, 7, v4
    v_sub_u32 v5, v3, v5
    v_cmp_le_u32 vcc, 28, v3
    s_nop 1
    v_cndmask_b32 v4, v4, v5, vcc
    v_cndmask_b32 v5, v5, 7, vcc
    v_lshrrev_b32 v6, 1, v4
    v_and_b32 v4, 1, v4
    v_lshlrev_b32 v6, 4, v6
    v_lshl_add_u32 v6, v4, 2, v6
    v_lshrrev_b32 v4, 2, v5
    v_and_b32 v5, 3, v5
    v_lshl_add_u32 v6, v4, 3, v6
    v_add_u32 v6, v6, v5
    v_and_b32 v4, 32, v2
    v_add_u32 v6, v6, v4
    s_and_b32 s35, s31, 8
    s_lshl_b32 s35, s35, 1
    v_xor_b32 v6, s35, v6
    v_lshlrev_b32 v27, 4, v6
    v_lshrrev_b32 v111, 4, v2
    v_bfe_u32 v108, v2, 2, 2
    v_and_b32 v1, 3, v2
    v_mul_u32_u24 v105, 896, v111
    v_lshl_add_u32 v105, v1, 3, v105
    v_and_b32 v1, 1, v111
    v_lshl_add_u32 v105, v1, 6, v105
    v_lshrrev_b32 v1, 1, v108
    v_lshl_add_u32 v105, v1, 5, v105
    v_add_u32 v105, 98304, v105
    v_lshl_add_u32 v96, v108, 7, v105
    v_min_u32 v108, 2, v108
    v_lshl_add_u32 v100, v108, 7, v105
    v_xor_b32 v97, 32, v96
    v_xor_b32 v101, 32, v100
    v_xor_b32 v98, 64, v96
    v_xor_b32 v102, 64, v100
    v_xor_b32 v99, 96, v96
    v_xor_b32 v103, 96, v100
    s_lshl_b32 s36, s29, 12
    s_add_u32 s35, s36, 32768
    v_add_u32 v104, s35, v7
    s_add_u32 s35, s36, 49152
    v_and_b32 v109, 15, v2
    v_mul_u32_u24 v106, 144, v109
    v_lshl_add_u32 v106, v111, 3, v106
    v_add_u32 v106, s35, v106
    v_lshrrev_b32 v1, 3, v2
    v_lshl_add_u32 v1, v1, 4, v7
    v_add_u32 v105, s35, v1
    v_lshlrev_b32 v110, 4, v111
    v_add_u32 v1, 1, v111
    v_lshrrev_b32 v1, 2, v1
    v_lshl_add_u32 v107, v1, 30, v7
    v_lshlrev_b32 v1, 4, v109
    v_add_u32 v111, 156928, v1
    s_lshl_b32 s35, s29, 4
    v_add_u32 v109, s35, v109
    v_lshlrev_b32 v108, 2, v109
    v_add_u32 v108, 156928, v108
    v_mov_b32 v16, 0
    v_mov_b32 v17, 0
    v_mov_b32 v18, 0
    v_mov_b32 v19, 0
    v_mov_b32 v28, 0
    v_mov_b32 v29, 0
    v_mov_b32 v30, 0
    v_mov_b32 v31, 0
    v_mfma_f32_32x32x16_bf16 v[128:143], v[16:19], v[16:19], 0
    v_mfma_f32_32x32x16_bf16 v[144:159], v[16:19], v[16:19], 0
    v_mfma_f32_32x32x16_bf16 v[160:175], v[16:19], v[16:19], 0
    v_mfma_f32_32x32x16_bf16 v[176:191], v[16:19], v[16:19], 0
    s_waitcnt lgkmcnt(0)
    s_barrier
    ds_read_b128 v[192:195], v8 offset:0
    ds_read_b128 v[196:199], v9 offset:0
    ds_read_b128 v[200:203], v10 offset:0
    ds_read_b128 v[204:207], v11 offset:0
    ds_read_b64_tr_b16 v[64:65], v12 offset:0
    ds_read_b64_tr_b16 v[66:67], v12 offset:512
    ds_read_b64_tr_b16 v[72:73], v12 offset:2048
    ds_read_b64_tr_b16 v[74:75], v12 offset:2560
    s_waitcnt lgkmcnt(7)
    v_dot2c_f32_bf16 v16, s57, v192
    v_dot2c_f32_bf16 v28, v192, v192
    ds_read_b64_tr_b16 v[80:81], v12 offset:4096
    v_dot2c_f32_bf16 v17, s57, v193
    v_dot2c_f32_bf16 v29, v193, v193
    ds_read_b64_tr_b16 v[82:83], v12 offset:4608
    v_dot2c_f32_bf16 v18, s57, v194
    v_dot2c_f32_bf16 v30, v194, v194
    ds_read_b64_tr_b16 v[88:89], v12 offset:6144
    v_dot2c_f32_bf16 v19, s57, v195
    v_dot2c_f32_bf16 v31, v195, v195
    ds_read_b64_tr_b16 v[90:91], v12 offset:6656
    s_waitcnt lgkmcnt(10)
    v_dot2c_f32_bf16 v16, s57, v196
    v_dot2c_f32_bf16 v28, v196, v196
    ds_read_b64_tr_b16 v[68:69], v13 offset:0
    v_dot2c_f32_bf16 v17, s57, v197
    v_dot2c_f32_bf16 v29, v197, v197
    ds_read_b64_tr_b16 v[70:71], v13 offset:512
    v_dot2c_f32_bf16 v18, s57, v198
    v_dot2c_f32_bf16 v30, v198, v198
    ds_read_b64_tr_b16 v[76:77], v13 offset:2048
    v_dot2c_f32_bf16 v19, s57, v199
    v_dot2c_f32_bf16 v31, v199, v199
    ds_read_b64_tr_b16 v[78:79], v13 offset:2560
    s_waitcnt lgkmcnt(13)
    v_dot2c_f32_bf16 v16, s57, v200
    v_dot2c_f32_bf16 v28, v200, v200
    ds_read_b64_tr_b16 v[84:85], v13 offset:4096
    v_dot2c_f32_bf16 v17, s57, v201
    v_dot2c_f32_bf16 v29, v201, v201
    ds_read_b64_tr_b16 v[86:87], v13 offset:4608
    v_dot2c_f32_bf16 v18, s57, v202
    v_dot2c_f32_bf16 v30, v202, v202
    v_dot2c_f32_bf16 v19, s57, v203
    v_dot2c_f32_bf16 v31, v203, v203
    s_waitcnt lgkmcnt(14)
    v_dot2c_f32_bf16 v16, s57, v204
    v_dot2c_f32_bf16 v28, v204, v204
    ds_read_b64_tr_b16 v[92:93], v13 offset:6144
    v_dot2c_f32_bf16 v17, s57, v205
    v_dot2c_f32_bf16 v29, v205, v205
    v_dot2c_f32_bf16 v18, s57, v206
    v_dot2c_f32_bf16 v30, v206, v206
    v_dot2c_f32_bf16 v19, s57, v207
    v_dot2c_f32_bf16 v31, v207, v207
    s_waitcnt lgkmcnt(9)
    ds_read_b64_tr_b16 v[94:95], v13 offset:6656
    v_mfma_f32_32x32x16_bf16 v[32:47], v[192:195], v[64:67], 0
    s_mov_b32 s8, s64
    s_mov_b32 s9, s65
    s_mov_b32 s10, 1835008
    s_mov_b32 s11, 0x00020000
    s_mov_b32 s16, s84
    s_mov_b32 s17, s85
    s_mov_b32 s18, 16777216
    v_mfma_f32_32x32x16_bf16 v[32:47], v[196:199], v[72:75], v[32:47]
    s_mov_b32 s19, 0x00020000
    s_mul_i32 s33, s33, 0x9e3779b1
    s_add_u32 s33, s33, 0x7f4a7c15
    s_mul_i32 s35, s51, 37
    s_lshr_b32 s35, s35, 8
    s_mul_i32 s36, s35, 7
    s_sub_u32 s54, s51, s36
    v_mfma_f32_32x32x16_bf16 v[32:47], v[200:203], v[80:83], v[32:47]
    s_lshl_b32 s36, s52, 2
    s_add_u32 s55, s36, s54
    s_min_u32 s35, s35, 3
    s_add_u32 s53, s36, s35
    s_lshl_b32 s35, s32, 3
    s_add_u32 s35, s35, s29
    s_lshl_b32 s36, s35, 12
    s_waitcnt lgkmcnt(8)
    v_mfma_f32_32x32x16_bf16 v[32:47], v[204:207], v[88:91], v[32:47]
    s_add_u32 s39, s36, 1064960
    s_lshl_b32 s35, s32, 6
    s_add_u32 s35, s35, s29
    s_lshl_b32 s36, s31, 2
    s_add_u32 s35, s35, s36
    s_lshl_b32 s36, s35, 11
    s_add_u32 s3, s36, 6292480
    s_waitcnt lgkmcnt(0)
    s_barrier
    v_mfma_f32_32x32x16_bf16 v[48:63], v[192:195], v[68:71], 0
    ds_read_b128 v[208:211], v8 offset:16384
    ds_read_b128 v[212:215], v9 offset:16384
    ds_read_b128 v[216:219], v10 offset:16384
    ds_read_b128 v[220:223], v11 offset:16384
    v_mfma_f32_32x32x16_bf16 v[48:63], v[196:199], v[76:79], v[48:63]
    ds_read_b64_tr_b16 v[224:225], v12 offset:8192
    ds_read_b64_tr_b16 v[226:227], v12 offset:8704
    ds_read_b64_tr_b16 v[232:233], v12 offset:10240
    ds_read_b64_tr_b16 v[234:235], v12 offset:10752
    v_mfma_f32_32x32x16_bf16 v[48:63], v[200:203], v[84:87], v[48:63]
    ds_read_b64_tr_b16 v[240:241], v12 offset:12288
    ds_read_b64_tr_b16 v[242:243], v12 offset:12800
    ds_read_b64_tr_b16 v[248:249], v12 offset:14336
    ds_read_b64_tr_b16 v[250:251], v12 offset:14848
    v_mfma_f32_32x32x16_bf16 v[48:63], v[204:207], v[92:95], v[48:63]
    ds_read_b64_tr_b16 v[228:229], v13 offset:8192
    ds_read_b64_tr_b16 v[230:231], v13 offset:8704
    ds_read_b64_tr_b16 v[236:237], v13 offset:10240
    s_waitcnt lgkmcnt(14)
    v_dot2c_f32_bf16 v16, s57, v208
    v_dot2c_f32_bf16 v28, v208, v208
    ds_read_b64_tr_b16 v[238:239], v13 offset:10752
    v_dot2c_f32_bf16 v17, s57, v209
    v_dot2c_f32_bf16 v29, v209, v209
    v_dot2c_f32_bf16 v18, s57, v210
    v_dot2c_f32_bf16 v30, v210, v210
    v_dot2c_f32_bf16 v19, s57, v211
    v_dot2c_f32_bf16 v31, v211, v211
    s_waitcnt lgkmcnt(14)
    v_dot2c_f32_bf16 v16, s57, v212
    v_dot2c_f32_bf16 v28, v212, v212
    ds_read_b64_tr_b16 v[244:245], v13 offset:12288
    v_dot2c_f32_bf16 v17, s57, v213
    v_dot2c_f32_bf16 v29, v213, v213
    v_dot2c_f32_bf16 v18, s57, v214
    v_dot2c_f32_bf16 v30, v214, v214
    v_dot2c_f32_bf16 v19, s57, v215
    v_dot2c_f32_bf16 v31, v215, v215
    s_waitcnt lgkmcnt(14)
    v_dot2c_f32_bf16 v16, s57, v216
    v_dot2c_f32_bf16 v28, v216, v216
    ds_read_b64_tr_b16 v[246:247], v13 offset:12800
    v_dot2c_f32_bf16 v17, s57, v217
    v_dot2c_f32_bf16 v29, v217, v217
    v_dot2c_f32_bf16 v18, s57, v218
    v_dot2c_f32_bf16 v30, v218, v218
    v_dot2c_f32_bf16 v19, s57, v219
    v_dot2c_f32_bf16 v31, v219, v219
    s_waitcnt lgkmcnt(14)
    v_dot2c_f32_bf16 v16, s57, v220
    v_dot2c_f32_bf16 v28, v220, v220
    ds_read_b64_tr_b16 v[252:253], v13 offset:14336
    v_dot2c_f32_bf16 v17, s57, v221
Lstop11:
    s_cbranch_execz Ltour_ret
    v_dot2c_f32_bf16 v29, v221, v221
    v_dot2c_f32_bf16 v18, s57, v222
    v_dot2c_f32_bf16 v30, v222, v222
    v_dot2c_f32_bf16 v19, s57, v223
    v_dot2c_f32_bf16 v31, v223, v223
    s_waitcnt lgkmcnt(9)
    ds_read_b64_tr_b16 v[254:255], v13 offset:14848
    v_mfma_f32_32x32x16_bf16 v[32:47], v[208:211], v[224:227], v[32:47]
    s_lshl_b32 s36, s35, 8
    s_add_u32 s4, s36, 786560
    s_lshl_b32 s36, s53, 1
    s_lshr_b32 s35, s29, 1
    s_add_u32 s35, s35, s36
    s_lshl_b32 s35, s35, 8
    s_lshr_b32 s36, s52, 2
    v_mfma_f32_32x32x16_bf16 v[32:47], v[212:215], v[232:235], v[32:47]
    s_xor_b32 s36, s36, 0
    s_lshl_b32 s36, s36, 17
    s_add_u32 s35, s35, s36
    s_add_u32 s5, s35, 786432
    v_bfe_u32 v1, v2, 1, 3
    v_and_b32 v4, 1, v2
    v_lshlrev_b32 v1, 14, v1
    v_mfma_f32_32x32x16_bf16 v[32:47], v[216:219], v[240:243], v[32:47]
    v_lshl_add_u32 v115, v4, 7, v1
    s_mul_i32 s35, s28, 12288
    v_add_u32 v113, s35, v7
    v_mov_b32 v120, 0
    v_mov_b32 v121, 0
    v_mov_b32 v122, 0
    v_mov_b32 v123, 0
    s_waitcnt lgkmcnt(8)
    v_mfma_f32_32x32x16_bf16 v[32:47], v[220:223], v[248:251], v[32:47]
    s_lshl_b32 s35, s52, 2
    s_add_u32 s35, s35, s29
    s_lshl_b32 s35, s35, 8
    s_add_u32 s38, s35, 12288
    s_mul_i32 s35, s31, 43
    s_lshr_b32 s35, s35, 8
    s_mul_i32 s35, s35, 6
    s_waitcnt lgkmcnt(0)
    s_barrier
    v_mfma_f32_32x32x16_bf16 v[48:63], v[208:211], v[228:231], v[48:63]
    ds_read_b128 v[192:195], v8 offset:32768
    ds_read_b128 v[196:199], v9 offset:32768
    ds_read_b128 v[200:203], v10 offset:32768
    ds_read_b128 v[204:207], v11 offset:32768
    v_mfma_f32_32x32x16_bf16 v[48:63], v[212:215], v[236:239], v[48:63]
    ds_read_b64_tr_b16 v[64:65], v12 offset:16384
    ds_read_b64_tr_b16 v[66:67], v12 offset:16896
    ds_read_b64_tr_b16 v[72:73], v12 offset:18432
    ds_read_b64_tr_b16 v[74:75], v12 offset:18944
    v_mfma_f32_32x32x16_bf16 v[48:63], v[216:219], v[244:247], v[48:63]
    ds_read_b64_tr_b16 v[80:81], v12 offset:20480
    ds_read_b64_tr_b16 v[82:83], v12 offset:20992
    ds_read_b64_tr_b16 v[88:89], v12 offset:22528
    ds_read_b64_tr_b16 v[90:91], v12 offset:23040
    v_mfma_f32_32x32x16_bf16 v[48:63], v[220:223], v[252:255], v[48:63]
    ds_read_b64_tr_b16 v[68:69], v13 offset:16384
    ds_read_b64_tr_b16 v[70:71], v13 offset:16896
    ds_read_b64_tr_b16 v[76:77], v13 offset:18432
    s_waitcnt lgkmcnt(14)
    v_dot2c_f32_bf16 v16, s57, v192
    v_dot2c_f32_bf16 v28, v192, v192
    ds_read_b64_tr_b16 v[78:79], v13 offset:18944
    v_dot2c_f32_bf16 v17, s57, v193
    v_dot2c_f32_bf16 v29, v193, v193
    v_dot2c_f32_bf16 v18, s57, v194
    v_dot2c_f32_bf16 v30, v194, v194
    v_dot2c_f32_bf16 v19, s57, v195
    v_dot2c_f32_bf16 v31, v195, v195
    s_waitcnt lgkmcnt(14)
    v_dot2c_f32_bf16 v16, s57, v196
    v_dot2c_f32_bf16 v28, v196, v196
    ds_read_b64_tr_b16 v[84:85], v13 offset:20480
    v_dot2c_f32_bf16 v17, s57, v197
    v_dot2c_f32_bf16 v29, v197, v197
    v_dot2c_f32_bf16 v18, s57, v198
    v_dot2c_f32_bf16 v30, v198, v198
    v_dot2c_f32_bf16 v19, s57, v199
    v_dot2c_f32_bf16 v31, v199, v199
    s_waitcnt lgkmcnt(14)
    v_dot2c_f32_bf16 v16, s57, v200
    v_dot2c_f32_bf16 v28, v200, v200
    ds_read_b64_tr_b16 v[86:87], v13 offset:20992
    v_dot2c_f32_bf16 v17, s57, v201
    v_dot2c_f32_bf16 v29, v201, v201
    v_dot2c_f32_bf16 v18, s57, v202
    v_dot2c_f32_bf16 v30, v202, v202
    v_dot2c_f32_bf16 v19, s57, v203
    v_dot2c_f32_bf16 v31, v203, v203
    s_waitcnt lgkmcnt(14)
    v_dot2c_f32_bf16 v16, s57, v204
    v_dot2c_f32_bf16 v28, v204, v204
    ds_read_b64_tr_b16 v[92:93], v13 offset:22528
    v_dot2c_f32_bf16 v17, s57, v205
    v_dot2c_f32_bf16 v29, v205, v205
    v_dot2c_f32_bf16 v18, s57, v206
    v_dot2c_f32_bf16 v30, v206, v206
    v_dot2c_f32_bf16 v19, s57, v207
    v_dot2c_f32_bf16 v31, v207, v207
    s_waitcnt lgkmcnt(9)
    ds_read_b64_tr_b16 v[94:95], v13 offset:23040
    v_mfma_f32_32x32x16_bf16 v[32:47], v[192:195], v[64:67], v[32:47]
    s_sub_u32 s40, s31, s35
    s_lshl_b32 s35, s53, 2
    s_add_u32 s35, s35, s29
    s_lshl_b32 s36, s35, 4
    v_lshrrev_b32 v1, 3, v2
    v_mul_u32_u24 v112, 896, v1
    s_mulk_i32 s36, 896
    v_mfma_f32_32x32x16_bf16 v[32:47], v[196:199], v[72:75], v[32:47]
    v_and_b32 v4, 0x70, v7
    v_add3_u32 v127, v112, v4, s36
    s_and_b32 s36, s29, 1
    s_lshl_b32 s37, s36, 6
    v_xor_b32 v4, s37, v4
    v_and_b32 v1, 16, v2
    v_lshlrev_b32 v1, 1, v1
    v_mfma_f32_32x32x16_bf16 v[32:47], v[200:203], v[80:83], v[32:47]
    v_xor_b32 v4, v1, v4
    v_add_u32 v112, v112, v4
    s_lshl_b32 s36, s36, 8
    v_and_b32 v1, 0xf0, v7
    v_and_b32 v4, 0x300, v7
    v_lshl_add_u32 v1, v4, 1, v1
    v_add_u32 v124, s36, v1
    s_waitcnt lgkmcnt(8)
    v_mfma_f32_32x32x16_bf16 v[32:47], v[204:207], v[88:91], v[32:47]
    s_lshl_b32 s71, s54, 7
    s_mul_i32 s36, s28, 6272
    s_mul_i32 s70, s28, 896
    s_mov_b32 s20, s68
    s_mov_b32 s21, s69
    s_mov_b32 s22, 401408
    s_mov_b32 s23, 0x00020000
    s_waitcnt lgkmcnt(0)
    s_barrier
    v_mfma_f32_32x32x16_bf16 v[48:63], v[192:195], v[68:71], v[48:63]
    ds_read_b128 v[208:211], v8 offset:49152
    ds_read_b128 v[212:215], v9 offset:49152
    ds_read_b128 v[216:219], v10 offset:49152
    ds_read_b128 v[220:223], v11 offset:49152
    v_mfma_f32_32x32x16_bf16 v[48:63], v[196:199], v[76:79], v[48:63]
    ds_read_b64_tr_b16 v[224:225], v12 offset:24576
    ds_read_b64_tr_b16 v[226:227], v12 offset:25088
Lstop12:
    s_cbranch_execz Lstop21
    ds_read_b64_tr_b16 v[232:233], v12 offset:26624
    ds_read_b64_tr_b16 v[234:235], v12 offset:27136
    v_mfma_f32_32x32x16_bf16 v[48:63], v[200:203], v[84:87], v[48:63]
    ds_read_b64_tr_b16 v[240:241], v12 offset:28672
    ds_read_b64_tr_b16 v[242:243], v12 offset:29184
    ds_read_b64_tr_b16 v[248:249], v12 offset:30720
    ds_read_b64_tr_b16 v[250:251], v12 offset:31232
    v_mfma_f32_32x32x16_bf16 v[48:63], v[204:207], v[92:95], v[48:63]
    ds_read_b64_tr_b16 v[228:229], v13 offset:24576
    ds_read_b64_tr_b16 v[230:231], v13 offset:25088
    ds_read_b64_tr_b16 v[236:237], v13 offset:26624
    s_waitcnt lgkmcnt(14)
    v_dot2c_f32_bf16 v16, s57, v208
    v_dot2c_f32_bf16 v28, v208, v208
    ds_read_b64_tr_b16 v[238:239], v13 offset:27136
    v_dot2c_f32_bf16 v17, s57, v209
    v_dot2c_f32_bf16 v29, v209, v209
    v_dot2c_f32_bf16 v18, s57, v210
    v_dot2c_f32_bf16 v30, v210, v210
    v_dot2c_f32_bf16 v19, s57, v211
    v_dot2c_f32_bf16 v31, v211, v211
    s_waitcnt lgkmcnt(14)
    v_dot2c_f32_bf16 v16, s57, v212
    v_dot2c_f32_bf16 v28, v212, v212
    ds_read_b64_tr_b16 v[244:245], v13 offset:28672
    v_dot2c_f32_bf16 v17, s57, v213
    v_dot2c_f32_bf16 v29, v213, v213
    v_dot2c_f32_bf16 v18, s57, v214
    v_dot2c_f32_bf16 v30, v214, v214
    v_dot2c_f32_bf16 v19, s57, v215
    v_dot2c_f32_bf16 v31, v215, v215
    s_waitcnt lgkmcnt(14)
    v_dot2c_f32_bf16 v16, s57, v216
    v_dot2c_f32_bf16 v28, v216, v216
    ds_read_b64_tr_b16 v[246:247], v13 offset:29184
    v_dot2c_f32_bf16 v17, s57, v217
    v_dot2c_f32_bf16 v29, v217, v217
    v_dot2c_f32_bf16 v18, s57, v218
    v_dot2c_f32_bf16 v30, v218, v218
    v_dot2c_f32_bf16 v19, s57, v219
    v_dot2c_f32_bf16 v31, v219, v219
    s_waitcnt lgkmcnt(14)
    v_dot2c_f32_bf16 v16, s57, v220
    v_dot2c_f32_bf16 v28, v220, v220
    ds_read_b64_tr_b16 v[252:253], v13 offset:30720
    v_dot2c_f32_bf16 v17, s57, v221
    v_dot2c_f32_bf16 v29, v221, v221
    v_dot2c_f32_bf16 v18, s57, v222
    v_dot2c_f32_bf16 v30, v222, v222
    v_dot2c_f32_bf16 v19, s57, v223
    v_dot2c_f32_bf16 v31, v223, v223
    s_waitcnt lgkmcnt(9)
    ds_read_b64_tr_b16 v[254:255], v13 offset:31232
    v_mfma_f32_32x32x16_bf16 v[32:47], v[208:211], v[224:227], v[32:47]
    s_lshl_b32 s37, s51, 3
    s_add_u32 s37, s37, s28
    s_mulk_i32 s37, 1664
    v_min_u32 v1, 12, v2
    v_lshl_add_u32 v117, v1, 7, s37
    s_add_u32 s71, s71, s36
    s_lshr_b32 s35, s51, 3
    v_mfma_f32_32x32x16_bf16 v[32:47], v[212:215], v[232:235], v[32:47]
    s_lshl_b32 s36, s52, 2
    s_add_u32 s35, s35, s36
    s_min_u32 s35, s35, 27
    s_cmp_eq_u32 s29, 1
    s_cselect_b64 s[24:25], s[74:75], s[76:77]
    s_add_u32 s36, s29, 1
    s_bitcmp0_b32 s36, 1
    v_mfma_f32_32x32x16_bf16 v[32:47], v[216:219], v[240:243], v[32:47]
    s_cselect_b64 s[24:25], s[78:79], s[24:25]
    s_mov_b32 s26, 1605632
    s_mov_b32 s27, 0x00020000
    s_movk_i32 s36, 128
    s_cselect_b32 s37, s36, 3584
    s_cselect_b32 s36, 57344, s36
    s_mul_i32 s36, s35, s36
    s_waitcnt lgkmcnt(8)
    v_mfma_f32_32x32x16_bf16 v[32:47], v[220:223], v[248:251], v[32:47]
    s_and_b32 s35, s51, 7
    s_mul_i32 s35, s35, 56
    s_mul_i32 s35, s35, s37
    s_add_u32 s36, s36, s35
    v_min_u32 v1, 55, v2
    v_mul_u32_u24 v1, s37, v1
    v_add_u32 v114, s36, v1
    s_waitcnt lgkmcnt(0)
    s_barrier
    v_mfma_f32_32x32x16_bf16 v[48:63], v[208:211], v[228:231], v[48:63]
    ds_read_b128 v[192:195], v8 offset:0
    ds_read_b128 v[196:199], v9 offset:0
    ds_read_b128 v[200:203], v10 offset:0
    ds_read_b128 v[204:207], v11 offset:0
    v_mfma_f32_32x32x16_bf16 v[48:63], v[212:215], v[236:239], v[48:63]
    ds_read_b64_tr_b16 v[64:65], v12 offset:0
    ds_read_b64_tr_b16 v[66:67], v12 offset:512
    ds_read_b64_tr_b16 v[72:73], v12 offset:2048
    ds_read_b64_tr_b16 v[74:75], v12 offset:2560
    v_mfma_f32_32x32x16_bf16 v[48:63], v[216:219], v[244:247], v[48:63]
    ds_read_b64_tr_b16 v[80:81], v12 offset:4096
    ds_read_b64_tr_b16 v[82:83], v12 offset:4608
    ds_read_b64_tr_b16 v[88:89], v12 offset:6144
    ds_read_b64_tr_b16 v[90:91], v12 offset:6656
    v_mfma_f32_32x32x16_bf16 v[48:63], v[220:223], v[252:255], v[48:63]
    ds_read_b64_tr_b16 v[68:69], v13 offset:0
    ds_read_b64_tr_b16 v[70:71], v13 offset:512
    ds_read_b64_tr_b16 v[76:77], v13 offset:2048
    s_waitcnt lgkmcnt(14)
    v_dot2c_f32_bf16 v16, s57, v192
    v_dot2c_f32_bf16 v28, v192, v192
    ds_read_b64_tr_b16 v[78:79], v13 offset:2560
    v_dot2c_f32_bf16 v17, s57, v193
    v_dot2c_f32_bf16 v29, v193, v193
    v_dot2c_f32_bf16 v18, s57, v194
    v_dot2c_f32_bf16 v30, v194, v194
    v_dot2c_f32_bf16 v19, s57, v195
    v_dot2c_f32_bf16 v31, v195, v195
    s_waitcnt lgkmcnt(14)
    v_dot2c_f32_bf16 v16, s57, v196
    v_dot2c_f32_bf16 v28, v196, v196
    ds_read_b64_tr_b16 v[84:85], v13 offset:4096
    v_dot2c_f32_bf16 v17, s57, v197
    v_dot2c_f32_bf16 v29, v197, v197
    v_dot2c_f32_bf16 v18, s57, v198
    v_dot2c_f32_bf16 v30, v198, v198
    v_dot2c_f32_bf16 v19, s57, v199
    v_dot2c_f32_bf16 v31, v199, v199
    s_waitcnt lgkmcnt(14)
    v_dot2c_f32_bf16 v16, s57, v200
    v_dot2c_f32_bf16 v28, v200, v200
    ds_read_b64_tr_b16 v[86:87], v13 offset:4608
    v_dot2c_f32_bf16 v17, s57, v201
    v_dot2c_f32_bf16 v29, v201, v201
    v_dot2c_f32_bf16 v18, s57, v202
    v_dot2c_f32_bf16 v30, v202, v202
    v_dot2c_f32_bf16 v19, s57, v203
    v_dot2c_f32_bf16 v31, v203, v203
    s_waitcnt lgkmcnt(14)
    v_dot2c_f32_bf16 v16, s57, v204
    v_dot2c_f32_bf16 v28, v204, v204
    ds_read_b64_tr_b16 v[92:93], v13 offset:6144
    v_dot2c_f32_bf16 v17, s57, v205
    v_dot2c_f32_bf16 v29, v205, v205
    v_dot2c_f32_bf16 v18, s57, v206
    v_dot2c_f32_bf16 v30, v206, v206
    v_dot2c_f32_bf16 v19, s57, v207
    v_dot2c_f32_bf16 v31, v207, v207
    s_waitcnt lgkmcnt(9)
    ds_read_b64_tr_b16 v[94:95], v13 offset:6656
    v_mfma_f32_32x32x16_bf16 v[32:47], v[192:195], v[64:67], v[32:47]
    s_and_b32 s35, s31, 7
    s_lshl_b32 s35, s35, 3
    s_add_u32 s35, s35, s52
    s_lshl_b32 s35, s35, 2
    s_lshr_b32 s36, s31, 3
    s_add_u32 s35, s35, s36
    s_lshl_b32 s35, s35, 2
    v_mfma_f32_32x32x16_bf16 v[32:47], v[196:199], v[72:75], v[32:47]
    s_add_u32 s35, s35, s29
    s_lshl_b32 s35, s35, 12
    s_lshr_b32 s36, s63, 3
    s_lshl_b32 s36, s36, 11
    s_add_u32 s35, s35, s36
    s_add_u32 s46, s35, 1048576
    s_add_u32 s47, s46, 32768
    v_mfma_f32_32x32x16_bf16 v[32:47], v[200:203], v[80:83], v[32:47]
    s_lshl_b32 s35, s52, 2
    s_add_u32 s35, s35, s29
    s_lshl_b32 s35, s35, 8
    s_lshl_b32 s36, s51, 2
    s_add_u32 s35, s35, s36
    s_add_u32 s61, s35, 12288
    s_lshl_b32 s35, s29, 2
    s_waitcnt lgkmcnt(8)
    v_mfma_f32_32x32x16_bf16 v[32:47], v[204:207], v[88:91], v[32:47]
    s_add_u32 s35, s35, 157248
    v_mov_b32 v118, s35
    s_sub_u32 s35, s5, 786432
    s_lshl_b32 s35, s35, 3
    s_add_u32 s35, s35, 6291456
    s_mov_b32 s36, 0
    s_lshl_b32 s37, s36, 19
    s_waitcnt lgkmcnt(0)
    s_barrier
    v_mfma_f32_32x32x16_bf16 v[48:63], v[192:195], v[68:71], v[48:63]
    ds_read_b128 v[208:211], v8 offset:16384
    ds_read_b128 v[212:215], v9 offset:16384
    ds_read_b128 v[216:219], v10 offset:16384
    ds_read_b128 v[220:223], v11 offset:16384
    v_mfma_f32_32x32x16_bf16 v[48:63], v[196:199], v[76:79], v[48:63]
    ds_read_b64_tr_b16 v[224:225], v12 offset:8192
    ds_read_b64_tr_b16 v[226:227], v12 offset:8704
    ds_read_b64_tr_b16 v[232:233], v12 offset:10240
    ds_read_b64_tr_b16 v[234:235], v12 offset:10752
    v_mfma_f32_32x32x16_bf16 v[48:63], v[200:203], v[84:87], v[48:63]
    ds_read_b64_tr_b16 v[240:241], v12 offset:12288
    ds_read_b64_tr_b16 v[242:243], v12 offset:12800
    ds_read_b64_tr_b16 v[248:249], v12 offset:14336
    ds_read_b64_tr_b16 v[250:251], v12 offset:14848
    v_mfma_f32_32x32x16_bf16 v[48:63], v[204:207], v[92:95], v[48:63]
    ds_read_b64_tr_b16 v[228:229], v13 offset:8192
    ds_read_b64_tr_b16 v[230:231], v13 offset:8704
    ds_read_b64_tr_b16 v[236:237], v13 offset:10240
    s_waitcnt lgkmcnt(14)
    v_dot2c_f32_bf16 v16, s57, v208
    v_dot2c_f32_bf16 v28, v208, v208
    ds_read_b64_tr_b16 v[238:239], v13 offset:10752
    v_dot2c_f32_bf16 v17, s57, v209
    v_dot2c_f32_bf16 v29, v209, v209
    v_dot2c_f32_bf16 v18, s57, v210
    v_dot2c_f32_bf16 v30, v210, v210
    v_dot2c_f32_bf16 v19, s57, v211
    v_dot2c_f32_bf16 v31, v211, v211
    s_waitcnt lgkmcnt(14)
    v_dot2c_f32_bf16 v16, s57, v212
    v_dot2c_f32_bf16 v28, v212, v212
    ds_read_b64_tr_b16 v[244:245], v13 offset:12288
    v_dot2c_f32_bf16 v17, s57, v213
    v_dot2c_f32_bf16 v29, v213, v213
    v_dot2c_f32_bf16 v18, s57, v214
    v_dot2c_f32_bf16 v30, v214, v214
    v_dot2c_f32_bf16 v19, s57, v215
    v_dot2c_f32_bf16 v31, v215, v215
Lstop13:
    s_cbranch_execz Ltour_ret
    s_waitcnt lgkmcnt(14)
    v_dot2c_f32_bf16 v16, s57, v216
    v_dot2c_f32_bf16 v28, v216, v216
    ds_read_b64_tr_b16 v[246:247], v13 offset:12800
    v_dot2c_f32_bf16 v17, s57, v217
    v_dot2c_f32_bf16 v29, v217, v217
    v_dot2c_f32_bf16 v18, s57, v218
    v_dot2c_f32_bf16 v30, v218, v218
    v_dot2c_f32_bf16 v19, s57, v219
    v_dot2c_f32_bf16 v31, v219, v219
    s_waitcnt lgkmcnt(14)
    v_dot2c_f32_bf16 v16, s57, v220
    v_dot2c_f32_bf16 v28, v220, v220
    ds_read_b64_tr_b16 v[252:253], v13 offset:14336
    v_dot2c_f32_bf16 v17, s57, v221
    v_dot2c_f32_bf16 v29, v221, v221
    v_dot2c_f32_bf16 v18, s57, v222
    v_dot2c_f32_bf16 v30, v222, v222
    v_dot2c_f32_bf16 v19, s57, v223
    v_dot2c_f32_bf16 v31, v223, v223
    s_waitcnt lgkmcnt(9)
    ds_read_b64_tr_b16 v[254:255], v13 offset:14848
    v_mfma_f32_32x32x16_bf16 v[32:47], v[208:211], v[224:227], v[32:47]
    s_sub_u32 s34, s35, s37
    s_add_u32 s6, s35, s37
    s_mul_i32 s35, s36, 14336
    s_lshl_b32 s48, s35, 1
    s_bfe_u32 s36, s5, 0x10011
    s_mulk_i32 s36, 28672
    s_add_u32 s35, s35, s36
    v_mfma_f32_32x32x16_bf16 v[32:47], v[212:215], v[232:235], v[32:47]
    v_add_u32 v96, s35, v96
    v_add_u32 v97, s35, v97
    v_add_u32 v98, s35, v98
    v_add_u32 v99, s35, v99
    v_add_u32 v100, s35, v100
    v_add_u32 v101, s35, v101
    v_add_u32 v102, s35, v102
    v_mfma_f32_32x32x16_bf16 v[32:47], v[216:219], v[240:243], v[32:47]
    v_add_u32 v103, s35, v103
    s_lshl_b32 s36, s53, 6
    v_add_u32 v109, s36, v109
    s_lshl_b32 s35, s29, 4
    s_add_u32 s35, s35, s36
    s_lshl_b32 s35, s35, 7
    s_add_u32 s49, s35, 524288
    s_waitcnt lgkmcnt(8)
    v_mfma_f32_32x32x16_bf16 v[32:47], v[220:223], v[248:251], v[32:47]
    s_lshl_b32 s35, s54, 8
    s_lshl_b32 s36, s36, 7
    s_add_u32 s35, s35, s36
    s_add_u32 s50, s35, 262144
    s_brev_b32 s82, 1
    s_movk_i32 s83, 0xf800
    s_waitcnt lgkmcnt(6)
    v_mfma_f32_32x32x16_bf16 v[48:63], v[208:211], v[228:231], v[48:63]
    s_waitcnt lgkmcnt(4)
    v_mfma_f32_32x32x16_bf16 v[48:63], v[212:215], v[236:239], v[48:63]
    s_waitcnt lgkmcnt(2)
    v_mfma_f32_32x32x16_bf16 v[48:63], v[216:219], v[244:247], v[48:63]
    s_waitcnt lgkmcnt(0)
    v_mfma_f32_32x32x16_bf16 v[48:63], v[220:223], v[252:255], v[48:63]
    s_waitcnt lgkmcnt(0)
    s_barrier
    ds_read_b128 v[192:195], v8 offset:32768
    ds_read_b128 v[196:199], v9 offset:32768
    ds_read_b128 v[200:203], v10 offset:32768
    ds_read_b128 v[204:207], v11 offset:32768
    ds_read_b64_tr_b16 v[64:65], v12 offset:16384
    ds_read_b64_tr_b16 v[66:67], v12 offset:16896
    ds_read_b64_tr_b16 v[72:73], v12 offset:18432
    ds_read_b64_tr_b16 v[74:75], v12 offset:18944
    s_waitcnt lgkmcnt(7)
    v_dot2c_f32_bf16 v16, s57, v192
    v_dot2c_f32_bf16 v28, v192, v192
    ds_read_b64_tr_b16 v[80:81], v12 offset:20480
    v_dot2c_f32_bf16 v17, s57, v193
    v_dot2c_f32_bf16 v29, v193, v193
    ds_read_b64_tr_b16 v[82:83], v12 offset:20992
    v_dot2c_f32_bf16 v18, s57, v194
    v_dot2c_f32_bf16 v30, v194, v194
    ds_read_b64_tr_b16 v[88:89], v12 offset:22528
    v_dot2c_f32_bf16 v19, s57, v195
    v_dot2c_f32_bf16 v31, v195, v195
    ds_read_b64_tr_b16 v[90:91], v12 offset:23040
    s_waitcnt lgkmcnt(10)
    v_dot2c_f32_bf16 v16, s57, v196
    v_dot2c_f32_bf16 v28, v196, v196
    ds_read_b64_tr_b16 v[68:69], v13 offset:16384
    v_dot2c_f32_bf16 v17, s57, v197
    v_dot2c_f32_bf16 v29, v197, v197
    ds_read_b64_tr_b16 v[70:71], v13 offset:16896
    v_dot2c_f32_bf16 v18, s57, v198
    v_dot2c_f32_bf16 v30, v198, v198
    ds_read_b64_tr_b16 v[76:77], v13 offset:18432
    v_dot2c_f32_bf16 v19, s57, v199
    v_dot2c_f32_bf16 v31, v199, v199
    ds_read_b64_tr_b16 v[78:79], v13 offset:18944
    s_waitcnt lgkmcnt(13)
    v_dot2c_f32_bf16 v16, s57, v200
    v_dot2c_f32_bf16 v28, v200, v200
    ds_read_b64_tr_b16 v[84:85], v13 offset:20480
    v_dot2c_f32_bf16 v17, s57, v201
    v_dot2c_f32_bf16 v29, v201, v201
    ds_read_b64_tr_b16 v[86:87], v13 offset:20992
    v_dot2c_f32_bf16 v18, s57, v202
    v_dot2c_f32_bf16 v30, v202, v202
    v_dot2c_f32_bf16 v19, s57, v203
    v_dot2c_f32_bf16 v31, v203, v203
    s_waitcnt lgkmcnt(14)
    v_dot2c_f32_bf16 v16, s57, v204
    v_dot2c_f32_bf16 v28, v204, v204
    ds_read_b64_tr_b16 v[92:93], v13 offset:22528
    v_dot2c_f32_bf16 v17, s57, v205
    v_dot2c_f32_bf16 v29, v205, v205
    v_dot2c_f32_bf16 v18, s57, v206
    v_dot2c_f32_bf16 v30, v206, v206
    v_dot2c_f32_bf16 v19, s57, v207
    v_dot2c_f32_bf16 v31, v207, v207
    s_waitcnt lgkmcnt(9)
    ds_read_b64_tr_b16 v[94:95], v13 offset:23040
    v_mfma_f32_32x32x16_bf16 v[32:47], v[192:195], v[64:67], v[32:47]
    v_add_f32 v16, v16, v17
    v_add_f32 v18, v18, v19
    v_add_f32 v28, v28, v29
    v_add_f32 v30, v30, v31
    v_add_f32 v16, v16, v18
    v_add_f32 v17, v28, v30
    v_mfma_f32_32x32x16_bf16 v[32:47], v[196:199], v[72:75], v[32:47]
    v_mov_b32 v24, v16
    v_mov_b32 v25, v17
    s_nop 0
    v_permlane32_swap_b32 v24, v16
    v_permlane32_swap_b32 v25, v17
    v_add_f32 v16, v24, v16
    v_add_f32 v17, v25, v17
    v_mfma_f32_32x32x16_bf16 v[32:47], v[200:203], v[80:83], v[32:47]
    v_mul_f32 v16, 0x3b124925, v16
    v_mul_f32 v17, 0x3b124925, v17
    v_fma_f32 v17, -v16, v16, v17
    v_max_f32 v17, 0, v17
    v_cvt_pk_bf16_f32 v24, v17, -v16
    v_lshlrev_b32 v17, 16, v24
    s_waitcnt lgkmcnt(8)
    v_mfma_f32_32x32x16_bf16 v[32:47], v[204:207], v[88:91], v[32:47]
    s_waitcnt lgkmcnt(0)
    s_barrier
    ds_read_b128 v[224:227], v119
    ds_read_b128 v[228:231], v119 offset:1024
    ds_read_b32 v118, v118
    v_add_f32 v17, 0x3727c5ac, v17
    v_cvt_pk_bf16_f32 v17, v17, v17
    v_lshlrev_b32 v17, 16, v17
    v_sqrt_f32 v17, v17
    v_and_b32 v20, 0xffff0000, v24
    v_cvt_pk_bf16_f32 v17, v17, v17
    v_mfma_f32_32x32x16_bf16 v[48:63], v[192:195], v[68:71], v[48:63]
    v_lshlrev_b32 v17, 16, v17
    v_rcp_f32 v22, v17
    v_alignbit_b32 v28, v20, v20, 16
    v_or_b32 v28, v28, v20
    v_mov_b32 v29, v28
    v_mov_b32 v30, v28
    v_mfma_f32_32x32x16_bf16 v[48:63], v[196:199], v[76:79], v[48:63]
    v_mov_b32 v31, v28
    ds_write_b32 v15, v22
    ds_read_b128 v[240:243], v26 offset:0
    ds_read_b128 v[244:247], v26 offset:32
    ds_read_b128 v[248:251], v26 offset:64
    ds_read_b128 v[252:255], v26 offset:96
    v_mfma_f32_32x32x16_bf16 v[48:63], v[200:203], v[84:87], v[48:63]
    v_mfma_f32_32x32x16_bf16 v[48:63], v[204:207], v[92:95], v[48:63]
    s_waitcnt lgkmcnt(5)
    v_mfma_f32_32x32x16_bf16 v[32:47], v[28:31], v[224:227], v[32:47]
    v_mfma_f32_32x32x16_bf16 v[48:63], v[28:31], v[228:231], v[48:63]
    v_readfirstlane_b32 s7, v118
    s_and_b32 s35, s31, 6
    s_cselect_b32 s43, 0, s7
    ds_write2_b32 v14, v28, v22 offset1:1
    s_mov_b32 exec_lo, 0xf0000000
    s_mov_b32 exec_hi, 0xf0000000
    v_mov_b32 v64, s57
    v_mov_b32 v65, s57
    v_mov_b32 v66, s57
    v_mov_b32 v67, s57
    v_mov_b32 v68, s57
    v_mov_b32 v69, s57
    v_mov_b32 v70, s57
    v_mov_b32 v71, s57
    v_mov_b32 v72, s57
    v_mov_b32 v73, s57
    v_mov_b32 v74, s57
    v_mov_b32 v75, s57
    v_mov_b32 v76, s57
    v_mov_b32 v77, s57
    v_mov_b32 v78, s57
    v_mov_b32 v79, s57
    s_waitcnt lgkmcnt(0)
    s_mov_b32 exec_lo, 0x0fffffff
    s_mov_b32 exec_hi, 0x0fffffff
    v_mul_f32 v32, v32, v240
    v_mul_f32 v33, v33, v241
    v_cvt_pk_bf16_f32 v64, v32, v33
    v_mul_f32 v34, v34, v242
    v_mul_f32 v35, v35, v243
    v_cvt_pk_bf16_f32 v65, v34, v35
    v_mul_f32 v36, v36, v244
    v_mul_f32 v37, v37, v245
    v_cvt_pk_bf16_f32 v66, v36, v37
    v_mul_f32 v38, v38, v246
    v_mul_f32 v39, v39, v247
    v_cvt_pk_bf16_f32 v67, v38, v39
    v_mul_f32 v40, v40, v248
    v_mul_f32 v41, v41, v249
    v_cvt_pk_bf16_f32 v68, v40, v41
    v_mul_f32 v42, v42, v250
    v_mul_f32 v43, v43, v251
    v_cvt_pk_bf16_f32 v69, v42, v43
    v_mul_f32 v44, v44, v252
    v_mul_f32 v45, v45, v253
    v_cvt_pk_bf16_f32 v70, v44, v45
    v_mul_f32 v46, v46, v254
    v_mul_f32 v47, v47, v255
    v_cvt_pk_bf16_f32 v71, v46, v47
    s_mov_b64 exec, -1
    s_cmp_eq_u32 s43, 0
    s_cbranch_scc1 Lglob_6
    buffer_store_dwordx4 v[64:67], v27, s[16:19], s46 offen
Lstop14:
    s_cbranch_execz Ltour_ret
    buffer_store_dwordx4 v[68:71], v27, s[16:19], s46 offen offset:1024
    s_branch Ljoin_7
Lglob_6:
    buffer_store_dwordx4 v[64:67], v27, s[16:19], s46 offen sc1
    buffer_store_dwordx4 v[68:71], v27, s[16:19], s46 offen offset:1024 sc1
Ljoin_7:
    s_mov_b32 exec_lo, 0x0fffffff
    s_mov_b32 exec_hi, 0x0fffffff
    v_mul_f32 v48, v48, v240
    v_mul_f32 v49, v49, v241
    v_cvt_pk_bf16_f32 v72, v48, v49
    v_mul_f32 v50, v50, v242
    v_mul_f32 v51, v51, v243
    v_cvt_pk_bf16_f32 v73, v50, v51
    v_mul_f32 v52, v52, v244
    v_mul_f32 v53, v53, v245
    v_cvt_pk_bf16_f32 v74, v52, v53
    v_mul_f32 v54, v54, v246
    v_mul_f32 v55, v55, v247
    v_cvt_pk_bf16_f32 v75, v54, v55
    v_mul_f32 v56, v56, v248
    v_mul_f32 v57, v57, v249
    v_cvt_pk_bf16_f32 v76, v56, v57
    v_mul_f32 v58, v58, v250
    v_mul_f32 v59, v59, v251
    v_cvt_pk_bf16_f32 v77, v58, v59
    v_mul_f32 v60, v60, v252
    v_mul_f32 v61, v61, v253
    v_cvt_pk_bf16_f32 v78, v60, v61
    v_mul_f32 v62, v62, v254
    v_mul_f32 v63, v63, v255
    v_cvt_pk_bf16_f32 v79, v62, v63
    s_mov_b64 exec, -1
    s_cmp_eq_u32 s43, 0
    s_cbranch_scc1 Lglob_8
    buffer_store_dwordx4 v[72:75], v27, s[16:19], s47 offen
    buffer_store_dwordx4 v[76:79], v27, s[16:19], s47 offen offset:1024
    s_branch Ljoin_9
Lglob_8:
    buffer_store_dwordx4 v[72:75], v27, s[16:19], s47 offen sc1
    buffer_store_dwordx4 v[76:79], v27, s[16:19], s47 offen offset:1024 sc1
Ljoin_9:
LcompQ:
Lstop15:
    s_cbranch_execz Lstop22
    s_setprio 0
    v_mov_b32 v4, s33
    v_mov_b32 v5, 156676
    v_mov_b32 v6, 1
    s_mov_b64 exec, 1
    ds_add_u32 v5, v6 offset:8
    s_mov_b64 exec, -1
    v_lshlrev_b32 v23, 2, v2
    s_add_u32 s35, s29, 1
    s_and_b32 s44, s35, 3
    s_lshl_b32 s35, s44, 11
    v_add_u32 v16, s35, v7
    s_add_u32 s35, s29, 2
    s_and_b32 s45, s35, 3
    s_lshl_b32 s35, s45, 11
    v_add_u32 v17, s35, v7
    s_add_u32 s35, s29, 3
    s_and_b32 s46, s35, 3
    s_lshl_b32 s35, s46, 11
    v_add_u32 v18, s35, v7
    s_add_u32 s35, s29, 4
    s_and_b32 s47, s35, 3
    s_lshl_b32 s35, s47, 11
    v_add_u32 v19, s35, v7
    buffer_load_dword v26, v23, s[16:19], s38 offen sc1
    s_waitcnt vmcnt(1)
    s_mov_b64 exec, 1
    s_cmp_eq_u32 s7, 0
    s_cbranch_scc1 Lglob_10
    buffer_store_dword v4, v120, s[16:19], s61 offen offset:0
Ljoin_11:
    s_mov_b64 exec, -1
    s_waitcnt vmcnt(1)
    v_cmp_ne_u32 vcc, s33, v26
    s_and_b32 s35, vcc_lo, vcc_hi
    s_lshr_b32 s36, s35, 16
    s_or_b32 s35, s35, s36
    s_lshr_b32 s35, s35, 8
    s_and_b32 s62, s35, 3
    s_cmp_eq_u32 s62, 3
    s_cbranch_scc0 Lpoll1x
Lpoll1:
    buffer_load_dword v26, v23, s[16:19], s38 offen sc1
    s_sub_u32 s58, s58, 1
    s_bitcmp1_b32 s58, 31
    s_cbranch_scc1 Lpoll1x
    s_waitcnt vmcnt(0)
    v_cmp_ne_u32 vcc, s33, v26
    s_and_b32 s35, vcc_lo, vcc_hi
    s_lshr_b32 s36, s35, 16
    s_or_b32 s35, s35, s36
    s_lshr_b32 s35, s35, 8
    s_and_b32 s62, s35, 3
    s_cmp_eq_u32 s62, 3
    s_cbranch_scc1 Lpoll1
Lpoll1x:
    s_and_b32 s59, s62, 1
    s_lshl_b32 s59, s59, 19
    s_add_u32 s41, s39, s59
    buffer_load_dwordx4 v[192:195], v7, s[16:19], s41 offen offset:0 sc1
    buffer_load_dwordx4 v[196:199], v7, s[16:19], s41 offen offset:1024 sc1
    buffer_load_dwordx4 v[200:203], v7, s[16:19], s41 offen offset:2048 sc1
    buffer_load_dwordx4 v[204:207], v7, s[16:19], s41 offen offset:3072 sc1
    s_barrier
Lattn:
Lstop16:
    s_cbranch_execz Lstop25
    ds_read_b128 v[48:51], v16 offset:0
    ds_read_b128 v[52:55], v16 offset:1024
    ds_read_b128 v[56:59], v17 offset:0
    ds_read_b128 v[60:63], v17 offset:1024
    ds_read_b128 v[64:67], v18 offset:0
    ds_read_b128 v[68:71], v18 offset:1024
    ds_read_b128 v[72:75], v19 offset:0
    ds_read_b128 v[76:79], v19 offset:1024
    v_mov_b32 v4, 0xdddddddd
    s_mul_i32 s36, s30, 51200
    s_mul_i32 s37, s30, -98304
    s_add_u32 s37, s37, 49152
    s_waitcnt vmcnt(2) lgkmcnt(6)
    v_mfma_f32_32x32x16_bf16 v[16:31], v[196:199], v[52:55], 0
    v_mfma_f32_32x32x16_bf16 v[16:31], v[192:195], v[48:51], v[16:31]
    s_mul_i32 s35, s44, 12288
    s_add_u32 s35, s35, s36
    v_add_u32 v8, s35, v7
    v_add_u32 v9, s37, v8
    s_mul_i32 s35, s45, 12288
    s_add_u32 s35, s35, s36
    v_add_u32 v10, s35, v7
    v_add_u32 v11, s37, v10
    s_mul_i32 s35, s46, 12288
    s_add_u32 s35, s35, s36
    v_add_u32 v12, s35, v7
    v_add_u32 v13, s37, v12
    s_waitcnt lgkmcnt(0)
    s_setprio 3
    v_exp_f32 v16, v16
    v_exp_f32 v17, v17
    v_exp_f32 v18, v18
    v_exp_f32 v19, v19
    s_waitcnt vmcnt(0)
    v_mfma_f32_32x32x16_bf16 v[32:47], v[196:199], v[60:63], 0
    v_exp_f32 v20, v20
    v_exp_f32 v21, v21
    v_exp_f32 v22, v22
    v_mfma_f32_32x32x16_bf16 v[32:47], v[192:195], v[56:59], v[32:47]
    s_cmp_lg_u32 s62, 0
    s_cbranch_scc1 Lm1
Lm1x:
    v_exp_f32 v23, v23
    v_exp_f32 v24, v24
    s_xor_b32 s41, s59, 524288
    s_add_u32 s41, s41, s39
    buffer_load_dwordx4 v[208:211], v7, s[16:19], s41 offen offset:0 sc1
    v_exp_f32 v25, v25
    v_exp_f32 v26, v26
    v_exp_f32 v27, v27
    v_smfmac_f32_32x32x32_bf16 v[128:143], v[200:203], v[16:23], v4
    buffer_load_dwordx4 v[212:215], v7, s[16:19], s41 offen offset:1024 sc1
    v_exp_f32 v28, v28
    v_exp_f32 v29, v29
    buffer_load_dwordx4 v[216:219], v7, s[16:19], s41 offen offset:2048 sc1
    v_exp_f32 v30, v30
    buffer_load_dwordx4 v[220:223], v7, s[16:19], s41 offen offset:3072 sc1
    v_exp_f32 v31, v31
    v_exp_f32 v32, v32
    v_exp_f32 v33, v33
    v_smfmac_f32_32x32x32_bf16 v[128:143], v[204:207], v[24:31], v4
    v_exp_f32 v34, v34
    v_exp_f32 v35, v35
    v_mfma_f32_32x32x16_bf16 v[16:31], v[196:199], v[68:71], 0
    v_exp_f32 v36, v36
    v_exp_f32 v37, v37
    v_exp_f32 v38, v38
    v_mfma_f32_32x32x16_bf16 v[16:31], v[192:195], v[64:67], v[16:31]
    v_exp_f32 v39, v39
    v_exp_f32 v40, v40
    v_exp_f32 v41, v41
    v_exp_f32 v42, v42
    v_exp_f32 v43, v43
    v_smfmac_f32_32x32x32_bf16 v[144:159], v[200:203], v[32:39], v4
    v_exp_f32 v44, v44
    v_exp_f32 v45, v45
    v_exp_f32 v46, v46
    v_exp_f32 v47, v47
    s_nop 1
    v_exp_f32 v16, v16
    v_exp_f32 v17, v17
    v_smfmac_f32_32x32x32_bf16 v[144:159], v[204:207], v[40:47], v4
    v_exp_f32 v18, v18
    v_exp_f32 v19, v19
    v_mfma_f32_32x32x16_bf16 v[32:47], v[196:199], v[76:79], 0
    v_exp_f32 v20, v20
    v_exp_f32 v21, v21
    v_exp_f32 v22, v22
    v_mfma_f32_32x32x16_bf16 v[32:47], v[192:195], v[72:75], v[32:47]
    v_lshrrev_b32 v14, 2, v7
    buffer_load_dword v15, v14, s[16:19], s38 offen sc1
    v_exp_f32 v23, v23
    v_exp_f32 v24, v24
    v_exp_f32 v25, v25
    v_exp_f32 v26, v26
    v_exp_f32 v27, v27
    v_smfmac_f32_32x32x32_bf16 v[160:175], v[200:203], v[16:23], v4
    v_exp_f32 v28, v28
    v_exp_f32 v29, v29
    v_exp_f32 v30, v30
    v_exp_f32 v31, v31
    v_exp_f32 v32, v32
    v_exp_f32 v33, v33
    v_smfmac_f32_32x32x32_bf16 v[160:175], v[204:207], v[24:31], v4
    v_exp_f32 v34, v34
    v_exp_f32 v35, v35
    s_waitcnt vmcnt(1)
    v_mfma_f32_32x32x16_bf16 v[16:31], v[212:215], v[52:55], 0
    v_exp_f32 v36, v36
    v_exp_f32 v37, v37
    v_exp_f32 v38, v38
    v_mfma_f32_32x32x16_bf16 v[16:31], v[208:211], v[48:51], v[16:31]
    s_waitcnt vmcnt(0)
    v_cmp_ne_u32 vcc, s33, v15
    s_and_b32 s35, vcc_lo, vcc_hi
    s_cbranch_scc1 Lfl
Lflx:
    v_exp_f32 v39, v39
    v_exp_f32 v40, v40
    s_add_u32 s41, s40, 2
    s_cmp_ge_u32 s41, 8
    s_cselect_b32 s35, 6, 0
    s_sub_u32 s41, s41, s35
    s_lshl_b32 s41, s41, 19
    s_add_u32 s41, s41, s39
    buffer_load_dwordx4 v[224:227], v7, s[16:19], s41 offen offset:0 sc1
    v_exp_f32 v41, v41
    v_exp_f32 v42, v42
    v_exp_f32 v43, v43
    v_smfmac_f32_32x32x32_bf16 v[176:191], v[200:203], v[32:39], v4
    buffer_load_dwordx4 v[228:231], v7, s[16:19], s41 offen offset:1024 sc1
    v_exp_f32 v44, v44
    v_exp_f32 v45, v45
    buffer_load_dwordx4 v[232:235], v7, s[16:19], s41 offen offset:2048 sc1
    v_exp_f32 v46, v46
    buffer_load_dwordx4 v[236:239], v7, s[16:19], s41 offen offset:3072 sc1
    v_exp_f32 v47, v47
    v_exp_f32 v16, v16
    v_exp_f32 v17, v17
    v_smfmac_f32_32x32x32_bf16 v[176:191], v[204:207], v[40:47], v4
    v_exp_f32 v18, v18
    v_exp_f32 v19, v19
    v_mfma_f32_32x32x16_bf16 v[32:47], v[212:215], v[60:63], 0
    v_exp_f32 v20, v20
    v_exp_f32 v21, v21
    v_exp_f32 v22, v22
    v_mfma_f32_32x32x16_bf16 v[32:47], v[208:211], v[56:59], v[32:47]
    v_exp_f32 v23, v23
    v_exp_f32 v24, v24
    v_exp_f32 v25, v25
    v_exp_f32 v26, v26
    v_exp_f32 v27, v27
    v_smfmac_f32_32x32x32_bf16 v[128:143], v[216:219], v[16:23], v4
    v_exp_f32 v28, v28
    v_exp_f32 v29, v29
    v_exp_f32 v30, v30
    v_exp_f32 v31, v31
    s_nop 1
    v_exp_f32 v32, v32
    v_exp_f32 v33, v33
    v_smfmac_f32_32x32x32_bf16 v[128:143], v[220:223], v[24:31], v4
    v_exp_f32 v34, v34
    v_exp_f32 v35, v35
    v_mfma_f32_32x32x16_bf16 v[16:31], v[212:215], v[68:71], 0
    v_exp_f32 v36, v36
    v_exp_f32 v37, v37
    v_exp_f32 v38, v38
    v_mfma_f32_32x32x16_bf16 v[16:31], v[208:211], v[64:67], v[16:31]
    v_exp_f32 v39, v39
    v_exp_f32 v40, v40
    v_exp_f32 v41, v41
    v_exp_f32 v42, v42
    v_exp_f32 v43, v43
    v_smfmac_f32_32x32x32_bf16 v[144:159], v[216:219], v[32:39], v4
    buffer_store_dwordx4 v[120:123], v7, s[16:19], s3 offen sc1
    v_exp_f32 v44, v44
    v_exp_f32 v45, v45
    v_exp_f32 v46, v46
    v_exp_f32 v47, v47
    s_nop 0
    v_exp_f32 v16, v16
    v_exp_f32 v17, v17
    v_smfmac_f32_32x32x32_bf16 v[144:159], v[220:223], v[40:47], v4
    v_exp_f32 v18, v18
    v_exp_f32 v19, v19
    v_mfma_f32_32x32x16_bf16 v[32:47], v[212:215], v[76:79], 0
    v_exp_f32 v20, v20
    v_exp_f32 v21, v21
    v_exp_f32 v22, v22
    v_mfma_f32_32x32x16_bf16 v[32:47], v[208:211], v[72:75], v[32:47]
    v_exp_f32 v23, v23
    v_exp_f32 v24, v24
    s_add_u32 s41, s40, 3
    s_cmp_ge_u32 s41, 8
    s_cselect_b32 s35, 6, 0
    s_sub_u32 s41, s41, s35
    s_lshl_b32 s41, s41, 19
    s_add_u32 s41, s41, s39
    buffer_load_dwordx4 v[240:243], v7, s[16:19], s41 offen offset:0 sc1
    v_exp_f32 v25, v25
    v_exp_f32 v26, v26
    v_exp_f32 v27, v27
    v_smfmac_f32_32x32x32_bf16 v[160:175], v[216:219], v[16:23], v4
    v_exp_f32 v28, v28
    v_exp_f32 v29, v29
    buffer_load_dwordx4 v[244:247], v7, s[16:19], s41 offen offset:1024 sc1
    v_exp_f32 v30, v30
    v_exp_f32 v31, v31
    v_exp_f32 v32, v32
    v_exp_f32 v33, v33
    v_smfmac_f32_32x32x32_bf16 v[160:175], v[220:223], v[24:31], v4
    v_exp_f32 v34, v34
    v_exp_f32 v35, v35
    s_waitcnt vmcnt(3)
    v_mfma_f32_32x32x16_bf16 v[16:31], v[228:231], v[52:55], 0
    v_exp_f32 v36, v36
    v_exp_f32 v37, v37
    v_exp_f32 v38, v38
    v_mfma_f32_32x32x16_bf16 v[16:31], v[224:227], v[48:51], v[16:31]
    v_exp_f32 v39, v39
    v_exp_f32 v40, v40
    buffer_load_dwordx4 v[248:251], v7, s[16:19], s41 offen offset:2048 sc1
    v_exp_f32 v41, v41
    v_exp_f32 v42, v42
    v_exp_f32 v43, v43
    v_smfmac_f32_32x32x32_bf16 v[176:191], v[216:219], v[32:39], v4
Lstop17:
    s_cbranch_execz Lstop26
    v_exp_f32 v44, v44
    v_exp_f32 v45, v45
    buffer_load_dwordx4 v[252:255], v7, s[16:19], s41 offen offset:3072 sc1
    v_exp_f32 v46, v46
    v_exp_f32 v47, v47
    v_exp_f32 v16, v16
    v_exp_f32 v17, v17
    v_smfmac_f32_32x32x32_bf16 v[176:191], v[220:223], v[40:47], v4
    v_exp_f32 v18, v18
    v_exp_f32 v19, v19
    v_mfma_f32_32x32x16_bf16 v[32:47], v[228:231], v[60:63], 0
    v_exp_f32 v20, v20
    v_exp_f32 v21, v21
    v_exp_f32 v22, v22
    v_mfma_f32_32x32x16_bf16 v[32:47], v[224:227], v[56:59], v[32:47]
    v_exp_f32 v23, v23
    s_setprio 2
    v_exp_f32 v24, v24
    s_add_u32 s41, s40, 4
    s_cmp_ge_u32 s41, 8
    s_cselect_b32 s35, 6, 0
    s_sub_u32 s41, s41, s35
    s_lshl_b32 s41, s41, 19
    s_add_u32 s41, s41, s39
    buffer_load_dwordx4 v[80:83], v7, s[16:19], s41 offen offset:0 sc1
    v_exp_f32 v25, v25
    v_exp_f32 v26, v26
    v_exp_f32 v27, v27
    v_smfmac_f32_32x32x32_bf16 v[128:143], v[232:235], v[16:23], v4
    v_exp_f32 v28, v28
    v_exp_f32 v29, v29
    buffer_load_dwordx4 v[84:87], v7, s[16:19], s41 offen offset:1024 sc1
    v_exp_f32 v30, v30
    v_exp_f32 v31, v31
    v_exp_f32 v32, v32
    v_exp_f32 v33, v33
    v_smfmac_f32_32x32x32_bf16 v[128:143], v[236:239], v[24:31], v4
    v_exp_f32 v34, v34
    v_exp_f32 v35, v35
    v_mfma_f32_32x32x16_bf16 v[16:31], v[228:231], v[68:71], 0
    v_exp_f32 v36, v36
    v_exp_f32 v37, v37
    v_exp_f32 v38, v38
    v_mfma_f32_32x32x16_bf16 v[16:31], v[224:227], v[64:67], v[16:31]
    v_exp_f32 v39, v39
    v_exp_f32 v40, v40
    buffer_load_dwordx4 v[88:91], v7, s[16:19], s41 offen offset:2048 sc1
    v_exp_f32 v41, v41
    v_exp_f32 v42, v42
    v_exp_f32 v43, v43
    v_smfmac_f32_32x32x32_bf16 v[144:159], v[232:235], v[32:39], v4
    v_exp_f32 v44, v44
    v_exp_f32 v45, v45
    buffer_load_dwordx4 v[92:95], v7, s[16:19], s41 offen offset:3072 sc1
    v_exp_f32 v46, v46
    v_exp_f32 v47, v47
    v_exp_f32 v16, v16
    v_exp_f32 v17, v17
    v_smfmac_f32_32x32x32_bf16 v[144:159], v[236:239], v[40:47], v4
    v_exp_f32 v18, v18
    v_exp_f32 v19, v19
    v_mfma_f32_32x32x16_bf16 v[32:47], v[228:231], v[76:79], 0
    v_exp_f32 v20, v20
    v_exp_f32 v21, v21
    v_exp_f32 v22, v22
    v_mfma_f32_32x32x16_bf16 v[32:47], v[224:227], v[72:75], v[32:47]
    v_exp_f32 v23, v23
    v_exp_f32 v24, v24
    s_add_u32 s41, s40, 5
    s_cmp_ge_u32 s41, 8
    s_cselect_b32 s35, 6, 0
    s_sub_u32 s41, s41, s35
    s_lshl_b32 s41, s41, 19
    s_add_u32 s41, s41, s39
    buffer_load_dwordx4 v[192:195], v7, s[16:19], s41 offen offset:0 sc1
    v_exp_f32 v25, v25
    v_exp_f32 v26, v26
    v_exp_f32 v27, v27
    v_smfmac_f32_32x32x32_bf16 v[160:175], v[232:235], v[16:23], v4
    v_exp_f32 v28, v28
    v_exp_f32 v29, v29
    buffer_load_dwordx4 v[196:199], v7, s[16:19], s41 offen offset:1024 sc1
    v_exp_f32 v30, v30
    v_exp_f32 v31, v31
    v_exp_f32 v32, v32
    v_exp_f32 v33, v33
    v_smfmac_f32_32x32x32_bf16 v[160:175], v[236:239], v[24:31], v4
    v_exp_f32 v34, v34
    v_exp_f32 v35, v35
    s_waitcnt vmcnt(6)
    v_mfma_f32_32x32x16_bf16 v[16:31], v[244:247], v[52:55], 0
    v_exp_f32 v36, v36
    v_exp_f32 v37, v37
    v_exp_f32 v38, v38
    v_mfma_f32_32x32x16_bf16 v[16:31], v[240:243], v[48:51], v[16:31]
    v_exp_f32 v39, v39
    v_exp_f32 v40, v40
    buffer_load_dwordx4 v[200:203], v7, s[16:19], s41 offen offset:2048 sc1
    v_exp_f32 v41, v41
    v_exp_f32 v42, v42
    v_exp_f32 v43, v43
    v_smfmac_f32_32x32x32_bf16 v[176:191], v[232:235], v[32:39], v4
    v_exp_f32 v44, v44
    v_exp_f32 v45, v45
    buffer_load_dwordx4 v[204:207], v7, s[16:19], s41 offen offset:3072 sc1
    v_exp_f32 v46, v46
    v_exp_f32 v47, v47
    v_exp_f32 v16, v16
    v_exp_f32 v17, v17
    v_smfmac_f32_32x32x32_bf16 v[176:191], v[236:239], v[40:47], v4
    v_exp_f32 v18, v18
    v_exp_f32 v19, v19
    v_mfma_f32_32x32x16_bf16 v[32:47], v[244:247], v[60:63], 0
    v_exp_f32 v20, v20
    v_exp_f32 v21, v21
    v_exp_f32 v22, v22
    v_mfma_f32_32x32x16_bf16 v[32:47], v[240:243], v[56:59], v[32:47]
    v_exp_f32 v23, v23
    v_exp_f32 v24, v24
    s_add_u32 s41, s40, 6
    s_cmp_ge_u32 s41, 8
    s_cselect_b32 s35, 6, 0
    s_sub_u32 s41, s41, s35
    s_lshl_b32 s41, s41, 19
    s_add_u32 s41, s41, s39
    buffer_load_dwordx4 v[208:211], v7, s[16:19], s41 offen offset:0 sc1
    v_exp_f32 v25, v25
    v_exp_f32 v26, v26
    v_exp_f32 v27, v27
    v_smfmac_f32_32x32x32_bf16 v[128:143], v[248:251], v[16:23], v4
    v_exp_f32 v28, v28
    v_exp_f32 v29, v29
    buffer_load_dwordx4 v[212:215], v7, s[16:19], s41 offen offset:1024 sc1
    v_exp_f32 v30, v30
    v_exp_f32 v31, v31
    s_setprio 1
    v_exp_f32 v32, v32
    v_exp_f32 v33, v33
    v_smfmac_f32_32x32x32_bf16 v[128:143], v[252:255], v[24:31], v4
    v_exp_f32 v34, v34
    v_exp_f32 v35, v35
    v_mfma_f32_32x32x16_bf16 v[16:31], v[244:247], v[68:71], 0
    v_exp_f32 v36, v36
    v_exp_f32 v37, v37
    v_exp_f32 v38, v38
    v_mfma_f32_32x32x16_bf16 v[16:31], v[240:243], v[64:67], v[16:31]
    v_exp_f32 v39, v39
    v_exp_f32 v40, v40
    buffer_load_dwordx4 v[216:219], v7, s[16:19], s41 offen offset:2048 sc1
    v_exp_f32 v41, v41
    v_exp_f32 v42, v42
    v_exp_f32 v43, v43
    v_smfmac_f32_32x32x32_bf16 v[144:159], v[248:251], v[32:39], v4
    v_exp_f32 v44, v44
    v_exp_f32 v45, v45
    buffer_load_dwordx4 v[220:223], v7, s[16:19], s41 offen offset:3072 sc1
    v_exp_f32 v46, v46
    v_exp_f32 v47, v47
    v_exp_f32 v16, v16
    v_exp_f32 v17, v17
    v_smfmac_f32_32x32x32_bf16 v[144:159], v[252:255], v[40:47], v4
    v_exp_f32 v18, v18
    v_exp_f32 v19, v19
    v_mfma_f32_32x32x16_bf16 v[32:47], v[244:247], v[76:79], 0
    v_exp_f32 v20, v20
    v_exp_f32 v21, v21
    v_exp_f32 v22, v22
    v_mfma_f32_32x32x16_bf16 v[32:47], v[240:243], v[72:75], v[32:47]
    v_mov_b32 v116, s33
    s_mov_b64 exec, 1
    buffer_store_dword v116, v120, s[16:19], s4 offen sc1
    s_mov_b64 exec, -1
    v_exp_f32 v23, v23
    v_exp_f32 v24, v24
    s_add_u32 s41, s40, 7
    s_cmp_ge_u32 s41, 8
    s_cselect_b32 s35, 6, 0
    s_sub_u32 s41, s41, s35
    s_lshl_b32 s41, s41, 19
    s_add_u32 s41, s41, s39
    buffer_load_dwordx4 v[224:227], v7, s[16:19], s41 offen offset:0 sc1
    v_exp_f32 v25, v25
    v_exp_f32 v26, v26
    v_exp_f32 v27, v27
    v_smfmac_f32_32x32x32_bf16 v[160:175], v[248:251], v[16:23], v4
    v_exp_f32 v28, v28
    v_exp_f32 v29, v29
    buffer_load_dwordx4 v[228:231], v7, s[16:19], s41 offen offset:1024 sc1
    v_exp_f32 v30, v30
    v_exp_f32 v31, v31
    v_exp_f32 v32, v32
    v_exp_f32 v33, v33
    v_smfmac_f32_32x32x32_bf16 v[160:175], v[252:255], v[24:31], v4
    v_exp_f32 v34, v34
    v_exp_f32 v35, v35
    s_waitcnt vmcnt(11)
    v_mfma_f32_32x32x16_bf16 v[16:31], v[84:87], v[52:55], 0
    s_setprio 0
    v_exp_f32 v36, v36
    v_exp_f32 v37, v37
    v_exp_f32 v38, v38
    v_mfma_f32_32x32x16_bf16 v[16:31], v[80:83], v[48:51], v[16:31]
    v_exp_f32 v39, v39
    v_exp_f32 v40, v40
    buffer_load_dwordx4 v[232:235], v7, s[16:19], s41 offen offset:2048 sc1
    v_exp_f32 v41, v41
    v_exp_f32 v42, v42
    v_exp_f32 v43, v43
    v_smfmac_f32_32x32x32_bf16 v[176:191], v[248:251], v[32:39], v4
    v_exp_f32 v44, v44
    v_exp_f32 v45, v45
    buffer_load_dwordx4 v[236:239], v7, s[16:19], s41 offen offset:3072 sc1
    v_exp_f32 v46, v46
    v_exp_f32 v47, v47
    v_exp_f32 v16, v16
    v_exp_f32 v17, v17
    v_smfmac_f32_32x32x32_bf16 v[176:191], v[252:255], v[40:47], v4
    v_exp_f32 v18, v18
    v_exp_f32 v19, v19
    s_waitcnt vmcnt(9)
    v_mfma_f32_32x32x16_bf16 v[32:47], v[196:199], v[52:55], 0
    v_exp_f32 v20, v20
    v_exp_f32 v21, v21
    v_exp_f32 v22, v22
    v_mfma_f32_32x32x16_bf16 v[32:47], v[192:195], v[48:51], v[32:47]
    s_barrier
    s_setprio 3
    v_exp_f32 v23, v23
    v_exp_f32 v24, v24
    buffer_load_dword v118, v117, s[20:23], 0 offen
    v_exp_f32 v25, v25
    v_exp_f32 v26, v26
    v_exp_f32 v27, v27
    v_smfmac_f32_32x32x32_bf16 v[128:143], v[88:91], v[16:23], v4
    v_exp_f32 v28, v28
    v_exp_f32 v29, v29
    buffer_load_dword v118, v114, s[24:27], 0 offen
    v_exp_f32 v30, v30
    v_exp_f32 v31, v31
    v_exp_f32 v32, v32
    v_exp_f32 v33, v33
    v_smfmac_f32_32x32x32_bf16 v[128:143], v[92:95], v[24:31], v4
    v_exp_f32 v34, v34
    v_exp_f32 v35, v35
    s_waitcnt vmcnt(7)
    v_mfma_f32_32x32x16_bf16 v[16:31], v[212:215], v[52:55], 0
Lstop18:
    s_cbranch_execz Ltour_ret
    v_exp_f32 v36, v36
    v_exp_f32 v37, v37
    v_exp_f32 v38, v38
    v_mfma_f32_32x32x16_bf16 v[16:31], v[208:211], v[48:51], v[16:31]
    v_exp_f32 v39, v39
    v_exp_f32 v40, v40
    v_exp_f32 v41, v41
    v_exp_f32 v42, v42
    v_exp_f32 v43, v43
    v_smfmac_f32_32x32x32_bf16 v[128:143], v[200:203], v[32:39], v4
    v_exp_f32 v44, v44
    v_exp_f32 v45, v45
    v_exp_f32 v46, v46
    v_exp_f32 v47, v47
    s_nop 1
    v_exp_f32 v16, v16
    v_exp_f32 v17, v17
    v_smfmac_f32_32x32x32_bf16 v[128:143], v[204:207], v[40:47], v4
    v_exp_f32 v18, v18
    v_exp_f32 v19, v19
    s_waitcnt vmcnt(2)
    v_mfma_f32_32x32x16_bf16 v[32:47], v[228:231], v[52:55], 0
    v_exp_f32 v20, v20
    v_exp_f32 v21, v21
    v_exp_f32 v22, v22
    v_mfma_f32_32x32x16_bf16 v[32:47], v[224:227], v[48:51], v[32:47]
    v_exp_f32 v23, v23
    v_exp_f32 v24, v24
    v_exp_f32 v25, v25
    v_exp_f32 v26, v26
    v_exp_f32 v27, v27
    v_smfmac_f32_32x32x32_bf16 v[128:143], v[216:219], v[16:23], v4
    v_exp_f32 v28, v28
    v_exp_f32 v29, v29
    v_exp_f32 v30, v30
    v_exp_f32 v31, v31
    s_nop 1
    v_exp_f32 v32, v32
    v_exp_f32 v33, v33
    v_smfmac_f32_32x32x32_bf16 v[128:143], v[220:223], v[24:31], v4
    v_exp_f32 v34, v34
    v_exp_f32 v35, v35
    v_mfma_f32_32x32x16_bf16 v[16:31], v[84:87], v[60:63], 0
    v_exp_f32 v36, v36
    v_exp_f32 v37, v37
    v_exp_f32 v38, v38
    v_mfma_f32_32x32x16_bf16 v[16:31], v[80:83], v[56:59], v[16:31]
    v_exp_f32 v39, v39
    v_exp_f32 v40, v40
    v_exp_f32 v41, v41
    v_exp_f32 v42, v42
    v_exp_f32 v43, v43
    v_smfmac_f32_32x32x32_bf16 v[128:143], v[232:235], v[32:39], v4
    v_exp_f32 v44, v44
    v_exp_f32 v45, v45
    v_exp_f32 v46, v46
    v_exp_f32 v47, v47
    s_nop 1
    v_exp_f32 v16, v16
    v_exp_f32 v17, v17
    v_smfmac_f32_32x32x32_bf16 v[128:143], v[236:239], v[40:47], v4
    v_exp_f32 v18, v18
    v_exp_f32 v19, v19
    v_mfma_f32_32x32x16_bf16 v[32:47], v[196:199], v[60:63], 0
    v_exp_f32 v20, v20
    v_exp_f32 v21, v21
    v_exp_f32 v22, v22
    v_mfma_f32_32x32x16_bf16 v[32:47], v[192:195], v[56:59], v[32:47]
    v_exp_f32 v23, v23
    v_exp_f32 v24, v24
    v_exp_f32 v25, v25
    v_exp_f32 v26, v26
    v_exp_f32 v27, v27
    v_smfmac_f32_32x32x32_bf16 v[144:159], v[88:91], v[16:23], v4
    ds_write_b128 v8, v[128:131] offset:0
    v_exp_f32 v28, v28
    v_exp_f32 v29, v29
    v_exp_f32 v30, v30
    v_exp_f32 v31, v31
    s_nop 0
    v_exp_f32 v32, v32
    v_exp_f32 v33, v33
    v_smfmac_f32_32x32x32_bf16 v[144:159], v[92:95], v[24:31], v4
    v_exp_f32 v34, v34
    v_exp_f32 v35, v35
    v_mfma_f32_32x32x16_bf16 v[16:31], v[212:215], v[60:63], 0
    v_exp_f32 v36, v36
    v_exp_f32 v37, v37
    v_exp_f32 v38, v38
    v_mfma_f32_32x32x16_bf16 v[16:31], v[208:211], v[56:59], v[16:31]
    v_exp_f32 v39, v39
    v_exp_f32 v40, v40
    v_exp_f32 v41, v41
    v_exp_f32 v42, v42
    v_exp_f32 v43, v43
    v_smfmac_f32_32x32x32_bf16 v[144:159], v[200:203], v[32:39], v4
    ds_write_b128 v8, v[132:135] offset:1024
    v_exp_f32 v44, v44
    v_exp_f32 v45, v45
    v_exp_f32 v46, v46
    v_exp_f32 v47, v47
    s_nop 0
    v_exp_f32 v16, v16
    v_exp_f32 v17, v17
    v_smfmac_f32_32x32x32_bf16 v[144:159], v[204:207], v[40:47], v4
    v_exp_f32 v18, v18
    v_exp_f32 v19, v19
    v_mfma_f32_32x32x16_bf16 v[32:47], v[228:231], v[60:63], 0
    v_exp_f32 v20, v20
    v_exp_f32 v21, v21
    v_exp_f32 v22, v22
    v_mfma_f32_32x32x16_bf16 v[32:47], v[224:227], v[56:59], v[32:47]
    v_exp_f32 v23, v23
    v_exp_f32 v24, v24
    v_exp_f32 v25, v25
    v_exp_f32 v26, v26
    v_exp_f32 v27, v27
    v_smfmac_f32_32x32x32_bf16 v[144:159], v[216:219], v[16:23], v4
    ds_write_b128 v9, v[136:139] offset:0
    v_exp_f32 v28, v28
    v_exp_f32 v29, v29
    v_exp_f32 v30, v30
    v_exp_f32 v31, v31
    s_nop 0
    v_exp_f32 v32, v32
    v_exp_f32 v33, v33
    v_smfmac_f32_32x32x32_bf16 v[144:159], v[220:223], v[24:31], v4
    v_exp_f32 v34, v34
    v_exp_f32 v35, v35
    v_mfma_f32_32x32x16_bf16 v[16:31], v[84:87], v[68:71], 0
    v_exp_f32 v36, v36
    v_exp_f32 v37, v37
    v_exp_f32 v38, v38
    v_mfma_f32_32x32x16_bf16 v[16:31], v[80:83], v[64:67], v[16:31]
    v_exp_f32 v39, v39
    v_exp_f32 v40, v40
    v_exp_f32 v41, v41
    v_exp_f32 v42, v42
    v_exp_f32 v43, v43
    v_smfmac_f32_32x32x32_bf16 v[144:159], v[232:235], v[32:39], v4
    ds_write_b128 v9, v[140:143] offset:1024
    v_exp_f32 v44, v44
    v_exp_f32 v45, v45
    v_exp_f32 v46, v46
    v_exp_f32 v47, v47
    s_setprio 2
    v_exp_f32 v16, v16
    v_exp_f32 v17, v17
    v_smfmac_f32_32x32x32_bf16 v[144:159], v[236:239], v[40:47], v4
    v_exp_f32 v18, v18
    v_exp_f32 v19, v19
    v_mfma_f32_32x32x16_bf16 v[32:47], v[196:199], v[68:71], 0
    v_exp_f32 v20, v20
    v_exp_f32 v21, v21
    v_exp_f32 v22, v22
    v_mfma_f32_32x32x16_bf16 v[32:47], v[192:195], v[64:67], v[32:47]
    v_exp_f32 v23, v23
    v_exp_f32 v24, v24
    v_exp_f32 v25, v25
    v_exp_f32 v26, v26
    v_exp_f32 v27, v27
    v_smfmac_f32_32x32x32_bf16 v[160:175], v[88:91], v[16:23], v4
    ds_write_b128 v10, v[144:147] offset:4096
    v_exp_f32 v28, v28
    v_exp_f32 v29, v29
    v_exp_f32 v30, v30
    v_exp_f32 v31, v31
    s_nop 0
    v_exp_f32 v32, v32
    v_exp_f32 v33, v33
    v_smfmac_f32_32x32x32_bf16 v[160:175], v[92:95], v[24:31], v4
    v_exp_f32 v34, v34
    v_exp_f32 v35, v35
    v_mfma_f32_32x32x16_bf16 v[16:31], v[212:215], v[68:71], 0
    v_exp_f32 v36, v36
    v_exp_f32 v37, v37
    v_exp_f32 v38, v38
    v_mfma_f32_32x32x16_bf16 v[16:31], v[208:211], v[64:67], v[16:31]
    v_exp_f32 v39, v39
    v_exp_f32 v40, v40
    v_exp_f32 v41, v41
    v_exp_f32 v42, v42
    v_exp_f32 v43, v43
    v_smfmac_f32_32x32x32_bf16 v[160:175], v[200:203], v[32:39], v4
    ds_write_b128 v10, v[148:151] offset:5120
    v_exp_f32 v44, v44
    v_exp_f32 v45, v45
    v_exp_f32 v46, v46
    v_exp_f32 v47, v47
    s_nop 0
    v_exp_f32 v16, v16
    v_exp_f32 v17, v17
    v_smfmac_f32_32x32x32_bf16 v[160:175], v[204:207], v[40:47], v4
    v_exp_f32 v18, v18
    v_exp_f32 v19, v19
    v_mfma_f32_32x32x16_bf16 v[32:47], v[228:231], v[68:71], 0
    v_exp_f32 v20, v20
    v_exp_f32 v21, v21
    v_exp_f32 v22, v22
    v_mfma_f32_32x32x16_bf16 v[32:47], v[224:227], v[64:67], v[32:47]
    v_exp_f32 v23, v23
    v_exp_f32 v24, v24
    s_add_u32 m0, s70, 98304
    s_add_u32 s35, s71, 0
    s_mov_b32 exec_hi, 0x00ffffff
    buffer_load_dwordx4 v112, s[20:23], s35 offen lds
    s_mov_b32 exec_hi, -1
    v_exp_f32 v25, v25
    v_exp_f32 v26, v26
    v_exp_f32 v27, v27
    v_smfmac_f32_32x32x32_bf16 v[160:175], v[216:219], v[16:23], v4
    ds_write_b128 v11, v[152:155] offset:4096
    v_exp_f32 v28, v28
    v_exp_f32 v29, v29
    s_add_u32 m0, s70, 105472
    s_add_u32 s35, s71, 50176
    s_mov_b32 exec_hi, 0x00ffffff
    buffer_load_dwordx4 v112, s[20:23], s35 offen lds
    s_mov_b32 exec_hi, -1
    v_exp_f32 v30, v30
    v_exp_f32 v31, v31
    v_exp_f32 v32, v32
    v_exp_f32 v33, v33
    v_smfmac_f32_32x32x32_bf16 v[160:175], v[220:223], v[24:31], v4
    v_exp_f32 v34, v34
    v_exp_f32 v35, v35
    v_mfma_f32_32x32x16_bf16 v[16:31], v[84:87], v[76:79], 0
    v_exp_f32 v36, v36
    v_exp_f32 v37, v37
    v_exp_f32 v38, v38
    v_mfma_f32_32x32x16_bf16 v[16:31], v[80:83], v[72:75], v[16:31]
    v_exp_f32 v39, v39
    v_exp_f32 v40, v40
    s_add_u32 m0, s70, 112640
    s_add_u32 s35, s71, 100352
    s_mov_b32 exec_hi, 0x00ffffff
    buffer_load_dwordx4 v112, s[20:23], s35 offen lds
    s_mov_b32 exec_hi, -1
    v_exp_f32 v41, v41
    v_exp_f32 v42, v42
    v_exp_f32 v43, v43
    v_smfmac_f32_32x32x32_bf16 v[160:175], v[232:235], v[32:39], v4
    ds_write_b128 v11, v[156:159] offset:5120
Lstop19:
    s_cbranch_execz Ltour_ret
    v_exp_f32 v44, v44
    v_exp_f32 v45, v45
    s_add_u32 m0, s70, 119808
    s_add_u32 s35, s71, 150528
    s_mov_b32 exec_hi, 0x00ffffff
    buffer_load_dwordx4 v112, s[20:23], s35 offen lds
    s_mov_b32 exec_hi, -1
    v_exp_f32 v46, v46
    v_exp_f32 v47, v47
    s_setprio 1
    v_exp_f32 v16, v16
    v_exp_f32 v17, v17
    v_smfmac_f32_32x32x32_bf16 v[160:175], v[236:239], v[40:47], v4
    v_exp_f32 v18, v18
    v_exp_f32 v19, v19
    v_mfma_f32_32x32x16_bf16 v[32:47], v[196:199], v[76:79], 0
    v_exp_f32 v20, v20
    v_exp_f32 v21, v21
    v_exp_f32 v22, v22
    v_mfma_f32_32x32x16_bf16 v[32:47], v[192:195], v[72:75], v[32:47]
    v_exp_f32 v23, v23
    v_exp_f32 v24, v24
    s_add_u32 m0, s70, 126976
    s_add_u32 s35, s71, 200704
    s_mov_b32 exec_hi, 0x00ffffff
    buffer_load_dwordx4 v112, s[20:23], s35 offen lds
    s_mov_b32 exec_hi, -1
    v_exp_f32 v25, v25
    v_exp_f32 v26, v26
    v_exp_f32 v27, v27
    v_smfmac_f32_32x32x32_bf16 v[176:191], v[88:91], v[16:23], v4
    ds_write_b128 v12, v[160:163] offset:8192
    v_exp_f32 v28, v28
    v_exp_f32 v29, v29
    s_add_u32 m0, s70, 134144
    s_add_u32 s35, s71, 250880
    s_mov_b32 exec_hi, 0x00ffffff
    buffer_load_dwordx4 v112, s[20:23], s35 offen lds
    s_mov_b32 exec_hi, -1
    v_exp_f32 v30, v30
    v_exp_f32 v31, v31
    v_exp_f32 v32, v32
    v_exp_f32 v33, v33
    v_smfmac_f32_32x32x32_bf16 v[176:191], v[92:95], v[24:31], v4
    v_exp_f32 v34, v34
    v_exp_f32 v35, v35
    v_mfma_f32_32x32x16_bf16 v[16:31], v[212:215], v[76:79], 0
    v_exp_f32 v36, v36
    v_exp_f32 v37, v37
    v_exp_f32 v38, v38
    v_mfma_f32_32x32x16_bf16 v[16:31], v[208:211], v[72:75], v[16:31]
    ds_write_b128 v12, v[164:167] offset:9216
    v_exp_f32 v39, v39
    v_exp_f32 v40, v40
    s_add_u32 m0, s70, 141312
    s_add_u32 s35, s71, 301056
    s_mov_b32 exec_hi, 0x00ffffff
    buffer_load_dwordx4 v112, s[20:23], s35 offen lds
    s_mov_b32 exec_hi, -1
    v_exp_f32 v41, v41
    v_exp_f32 v42, v42
    v_exp_f32 v43, v43
    v_smfmac_f32_32x32x32_bf16 v[176:191], v[200:203], v[32:39], v4
    v_exp_f32 v44, v44
    v_exp_f32 v45, v45
    s_add_u32 m0, s70, 148480
    s_add_u32 s35, s71, 351232
    s_mov_b32 exec_hi, 0x00ffffff
    buffer_load_dwordx4 v112, s[20:23], s35 offen lds
    s_mov_b32 exec_hi, -1
    v_exp_f32 v46, v46
    ds_write_b128 v13, v[168:171] offset:8192
    v_exp_f32 v47, v47
    s_setprio 0
    v_exp_f32 v16, v16
    v_exp_f32 v17, v17
    v_smfmac_f32_32x32x32_bf16 v[176:191], v[204:207], v[40:47], v4
    buffer_load_dword v116, v115, s[16:19], s5 offen sc1
    v_exp_f32 v18, v18
    v_exp_f32 v19, v19
    v_mfma_f32_32x32x16_bf16 v[32:47], v[228:231], v[76:79], 0
    v_exp_f32 v20, v20
    v_exp_f32 v21, v21
    v_exp_f32 v22, v22
    v_mfma_f32_32x32x16_bf16 v[32:47], v[224:227], v[72:75], v[32:47]
    v_exp_f32 v23, v23
    v_exp_f32 v24, v24
    v_exp_f32 v25, v25
    v_exp_f32 v26, v26
    v_exp_f32 v27, v27
    v_smfmac_f32_32x32x32_bf16 v[176:191], v[216:219], v[16:23], v4
    ds_write_b128 v13, v[172:175] offset:9216
    v_exp_f32 v28, v28
    v_exp_f32 v29, v29
    v_exp_f32 v30, v30
    s_waitcnt lgkmcnt(0)
    s_barrier
    ds_read_b128 v[128:131], v113 offset:0
    ds_read_b128 v[132:135], v113 offset:1024
    ds_read_b128 v[136:139], v113 offset:2048
    s_setprio 1
    v_exp_f32 v31, v31
    v_exp_f32 v32, v32
    v_exp_f32 v33, v33
    v_smfmac_f32_32x32x32_bf16 v[176:191], v[220:223], v[24:31], v4
    ds_read_b128 v[140:143], v113 offset:3072
    ds_read_b128 v[144:147], v113 offset:4096
    ds_read_b128 v[148:151], v113 offset:5120
    v_exp_f32 v34, v34
    v_exp_f32 v35, v35
    v_exp_f32 v36, v36
    v_exp_f32 v37, v37
    v_exp_f32 v38, v38
    ds_read_b128 v[152:155], v113 offset:6144
    ds_read_b128 v[156:159], v113 offset:7168
    ds_read_b128 v[160:163], v113 offset:8192
    v_exp_f32 v39, v39
    v_exp_f32 v40, v40
    ds_read_b128 v[164:167], v113 offset:9216
    ds_read_b128 v[168:171], v113 offset:10240
    ds_read_b128 v[172:175], v113 offset:11264
    s_setprio 0
    v_exp_f32 v41, v41
    v_exp_f32 v42, v42
    v_exp_f32 v43, v43
    v_smfmac_f32_32x32x32_bf16 v[176:191], v[232:235], v[32:39], v4
    v_exp_f32 v44, v44
    v_exp_f32 v45, v45
    v_exp_f32 v46, v46
    v_exp_f32 v47, v47
    s_xor_b32 s35, s28, 4
    s_mulk_i32 s35, 12288
    v_smfmac_f32_32x32x32_bf16 v[176:191], v[236:239], v[40:47], v4
    v_add_u32 v5, s35, v7
    v_mov_b32 v6, 156672
    s_mov_b32 s36, 0x3f000000
    s_waitcnt lgkmcnt(0)
    v_pk_add_f32 v[134:135], v[134:135], v[142:143]
    v_pk_add_f32 v[150:151], v[150:151], v[158:159]
    v_pk_add_f32 v[166:167], v[166:167], v[174:175]
    v_pk_add_f32 v[134:135], v[134:135], v[150:151]
    v_pk_add_f32 v[134:135], v[134:135], v[166:167]
    v_pk_add_f32 v[132:133], v[132:133], v[140:141]
    v_pk_add_f32 v[148:149], v[148:149], v[156:157]
    v_pk_add_f32 v[164:165], v[164:165], v[172:173]
    ds_write_b128 v113, v[184:187]
    ds_write_b128 v113, v[188:191] offset:1024
    v_pk_add_f32 v[182:183], v[182:183], v[134:135]
    v_cmp_nge_f32 s[44:45], s36, v183
    v_cmp_nle_f32 vcc, 0x1c800000, v183
    v_pk_add_f32 v[132:133], v[132:133], v[148:149]
    v_pk_add_f32 v[132:133], v[132:133], v[164:165]
    v_pk_add_f32 v[180:181], v[180:181], v[132:133]
    s_or_b64 vcc, s[44:45], vcc
    s_cbranch_scc1 Lbad
Lbadx:
    s_waitcnt vmcnt(0) lgkmcnt(0)
    s_barrier
    ds_read_b128 v[20:23], v5 offset:1024
    ds_read_b128 v[16:19], v5
    ds_read_b32 v26, v6
    v_pk_add_f32 v[128:129], v[128:129], v[136:137]
    v_pk_add_f32 v[130:131], v[130:131], v[138:139]
    v_pk_add_f32 v[144:145], v[144:145], v[152:153]
    v_pk_add_f32 v[146:147], v[146:147], v[154:155]
    v_pk_add_f32 v[160:161], v[160:161], v[168:169]
    v_pk_add_f32 v[162:163], v[162:163], v[170:171]
    v_pk_add_f32 v[128:129], v[128:129], v[144:145]
    v_pk_add_f32 v[130:131], v[130:131], v[146:147]
    v_pk_add_f32 v[128:129], v[128:129], v[160:161]
    v_pk_add_f32 v[130:131], v[130:131], v[162:163]
    v_pk_add_f32 v[176:177], v[176:177], v[128:129]
    v_pk_add_f32 v[178:179], v[178:179], v[130:131]
    s_waitcnt lgkmcnt(2)
    v_add_f32 v23, v23, v183
    v_rcp_f32 v24, v23
    v_pk_add_f32 v[20:21], v[20:21], v[180:181]
    v_add_f32 v22, v22, v182
    s_waitcnt lgkmcnt(0)
    v_readfirstlane_b32 s35, v26
    v_pk_add_f32 v[16:17], v[16:17], v[176:177]
    v_pk_add_f32 v[18:19], v[18:19], v[178:179]
    v_mul_f32 v22, v22, v24
    v_pk_mul_f32 v[16:17], v[16:17], v[24:25] op_sel_hi:[1,0]
    v_pk_mul_f32 v[18:19], v[18:19], v[24:25] op_sel_hi:[1,0]
    v_pk_mul_f32 v[20:21], v[20:21], v[24:25] op_sel_hi:[1,0]
    v_cvt_pk_bf16_f32 v31, v22, -v120
    v_cvt_pk_bf16_f32 v28, v16, v17
    v_cvt_pk_bf16_f32 v29, v18, v19
    v_cvt_pk_bf16_f32 v30, v20, v21
    s_cmp_gt_u32 s35, s56
    s_cbranch_scc1 Lfallback
    buffer_store_dwordx4 v[28:31], v7, s[16:19], s3 offen sc1
    s_cmp_ge_u32 s51, 28
    s_cbranch_scc1 Lffn
    s_lshl_b32 s42, s54, 7
    s_add_u32 s43, s42, 7168
    s_cmp_eq_u32 s30, 1
    s_cbranch_scc1 Lg1
    buffer_load_dwordx4 v[80:83], v127, s[8:11], s42 offen
    buffer_load_dwordx4 v[84:87], v127, s[8:11], s43 offen
    ds_read_b64_tr_b16 v[128:129], v96 offset:0
    ds_read_b64_tr_b16 v[130:131], v100 offset:512
    ds_read_b64_tr_b16 v[132:133], v97 offset:0
Lstop20:
    s_cbranch_execz Ltour_ret
    ds_read_b64_tr_b16 v[134:135], v101 offset:512
    ds_read_b64_tr_b16 v[136:137], v98 offset:0
    ds_read_b64_tr_b16 v[138:139], v102 offset:512
    ds_read_b64_tr_b16 v[140:141], v99 offset:0
    ds_read_b64_tr_b16 v[142:143], v103 offset:512
    v_cmp_ne_u32 vcc, s33, v116
    s_cbranch_vccnz Lclr0
Lclr_ok0:
    s_barrier
    s_waitcnt lgkmcnt(7)
    ds_read_b64_tr_b16 v[144:145], v96 offset:3584
    ds_read_b64_tr_b16 v[146:147], v100 offset:4096
    ds_read_b64_tr_b16 v[148:149], v97 offset:3584
    ds_read_b64_tr_b16 v[150:151], v101 offset:4096
    ds_read_b64_tr_b16 v[152:153], v98 offset:3584
    ds_read_b64_tr_b16 v[154:155], v102 offset:4096
    ds_read_b64_tr_b16 v[156:157], v99 offset:3584
    ds_read_b64_tr_b16 v[158:159], v103 offset:4096
    s_waitcnt lgkmcnt(7)
    ds_read_b64_tr_b16 v[160:161], v96 offset:7168
    ds_read_b64_tr_b16 v[162:163], v100 offset:7680
    ds_read_b64_tr_b16 v[164:165], v97 offset:7168
    ds_read_b64_tr_b16 v[166:167], v101 offset:7680
    ds_read_b64_tr_b16 v[168:169], v98 offset:7168
    ds_read_b64_tr_b16 v[170:171], v102 offset:7680
    ds_read_b64_tr_b16 v[172:173], v99 offset:7168
    ds_read_b64_tr_b16 v[174:175], v103 offset:7680
    s_waitcnt lgkmcnt(7)
    ds_read_b64_tr_b16 v[176:177], v96 offset:10752
    ds_read_b64_tr_b16 v[178:179], v100 offset:11264
    ds_read_b64_tr_b16 v[180:181], v97 offset:10752
    ds_read_b64_tr_b16 v[182:183], v101 offset:11264
    ds_read_b64_tr_b16 v[184:185], v98 offset:10752
    ds_read_b64_tr_b16 v[186:187], v102 offset:11264
    ds_read_b64_tr_b16 v[188:189], v99 offset:10752
    ds_read_b64_tr_b16 v[190:191], v103 offset:11264
    s_waitcnt lgkmcnt(7)
    ds_read_b64_tr_b16 v[192:193], v96 offset:14336
    ds_read_b64_tr_b16 v[194:195], v100 offset:14848
    ds_read_b64_tr_b16 v[196:197], v97 offset:14336
    ds_read_b64_tr_b16 v[198:199], v101 offset:14848
    ds_read_b64_tr_b16 v[200:201], v98 offset:14336
    ds_read_b64_tr_b16 v[202:203], v102 offset:14848
    ds_read_b64_tr_b16 v[204:205], v99 offset:14336
    ds_read_b64_tr_b16 v[206:207], v103 offset:14848
    s_add_u32 s35, s6, 0
    buffer_load_dwordx4 v[32:35], v124, s[16:19], s35 offen sc1
    s_add_u32 s35, s6, 131072
    buffer_load_dwordx4 v[36:39], v124, s[16:19], s35 offen sc1
    s_add_u32 s35, s6, 262144
    buffer_load_dwordx4 v[40:43], v124, s[16:19], s35 offen sc1
    s_add_u32 s35, s6, 393216
    buffer_load_dwordx4 v[44:47], v124, s[16:19], s35 offen sc1
    s_waitcnt lgkmcnt(7)
    ds_read_b64_tr_b16 v[208:209], v96 offset:17920
    ds_read_b64_tr_b16 v[210:211], v100 offset:18432
    ds_read_b64_tr_b16 v[212:213], v97 offset:17920
    ds_read_b64_tr_b16 v[214:215], v101 offset:18432
    ds_read_b64_tr_b16 v[216:217], v98 offset:17920
    ds_read_b64_tr_b16 v[218:219], v102 offset:18432
Lstop21:
    s_cbranch_execz Lstop29
    ds_read_b64_tr_b16 v[220:221], v99 offset:17920
    ds_read_b64_tr_b16 v[222:223], v103 offset:18432
    s_waitcnt lgkmcnt(7)
    ds_read_b64_tr_b16 v[224:225], v96 offset:21504
    ds_read_b64_tr_b16 v[226:227], v100 offset:22016
    ds_read_b64_tr_b16 v[228:229], v97 offset:21504
    ds_read_b64_tr_b16 v[230:231], v101 offset:22016
    ds_read_b64_tr_b16 v[232:233], v98 offset:21504
    ds_read_b64_tr_b16 v[234:235], v102 offset:22016
    ds_read_b64_tr_b16 v[236:237], v99 offset:21504
    ds_read_b64_tr_b16 v[238:239], v103 offset:22016
    s_waitcnt lgkmcnt(7)
    ds_read_b64_tr_b16 v[240:241], v96 offset:25088
    ds_read_b64_tr_b16 v[242:243], v100 offset:25600
    ds_read_b64_tr_b16 v[244:245], v97 offset:25088
    ds_read_b64_tr_b16 v[246:247], v101 offset:25600
    ds_read_b64_tr_b16 v[248:249], v98 offset:25088
    ds_read_b64_tr_b16 v[250:251], v102 offset:25600
    ds_read_b64_tr_b16 v[252:253], v99 offset:25088
    ds_read_b64_tr_b16 v[254:255], v103 offset:25600
    s_waitcnt lgkmcnt(9)
    s_waitcnt vmcnt(4)
    ds_write_b128 v105, v[80:83]
    ds_write_b128 v105, v[84:87] offset:1152
    ds_read_b64 v[64:65], v106 offset:0
    ds_read_b64 v[66:67], v106 offset:32
    ds_read_b64 v[68:69], v106 offset:64
    ds_read_b64 v[70:71], v106 offset:96
    s_add_u32 s35, s34, 524288
    buffer_load_dwordx4 v[48:51], v124, s[16:19], s35 offen sc1
    s_add_u32 s35, s34, 655360
    buffer_load_dwordx4 v[52:55], v124, s[16:19], s35 offen sc1
    s_add_u32 s35, s34, 786432
    buffer_load_dwordx4 v[56:59], v124, s[16:19], s35 offen sc1
    s_add_u32 s35, s34, 917504
    buffer_load_dwordx4 v[60:63], v124, s[16:19], s35 offen sc1
    s_waitcnt lgkmcnt(0)
    v_lshlrev_b32 v16, 16, v64
    v_and_b32 v17, 0xffff0000, v64
    v_lshlrev_b32 v18, 16, v65
    v_and_b32 v19, 0xffff0000, v65
    v_lshlrev_b32 v20, 16, v66
    v_and_b32 v21, 0xffff0000, v66
    v_lshlrev_b32 v22, 16, v67
    v_and_b32 v23, 0xffff0000, v67
    v_lshlrev_b32 v24, 16, v68
    v_and_b32 v25, 0xffff0000, v68
    v_lshlrev_b32 v26, 16, v69
    v_and_b32 v27, 0xffff0000, v69
    v_lshlrev_b32 v28, 16, v70
    v_and_b32 v29, 0xffff0000, v70
    v_lshlrev_b32 v30, 16, v71
    v_and_b32 v31, 0xffff0000, v71
    s_waitcnt vmcnt(7)
    v_mfma_f32_16x16x32_bf16 v[16:19], v[128:131], v[32:35], v[16:19]
    v_mfma_f32_16x16x32_bf16 v[20:23], v[132:135], v[32:35], v[20:23]
    v_mfma_f32_16x16x32_bf16 v[24:27], v[136:139], v[32:35], v[24:27]
    v_mfma_f32_16x16x32_bf16 v[28:31], v[140:143], v[32:35], v[28:31]
    s_waitcnt vmcnt(6)
    v_mfma_f32_16x16x32_bf16 v[16:19], v[144:147], v[36:39], v[16:19]
    v_mfma_f32_16x16x32_bf16 v[20:23], v[148:151], v[36:39], v[20:23]
    v_mfma_f32_16x16x32_bf16 v[24:27], v[152:155], v[36:39], v[24:27]
    v_mfma_f32_16x16x32_bf16 v[28:31], v[156:159], v[36:39], v[28:31]
    v_and_b32 v3, v35, v39
    s_waitcnt vmcnt(5)
    v_mfma_f32_16x16x32_bf16 v[16:19], v[160:163], v[40:43], v[16:19]
    v_mfma_f32_16x16x32_bf16 v[20:23], v[164:167], v[40:43], v[20:23]
    v_mfma_f32_16x16x32_bf16 v[24:27], v[168:171], v[40:43], v[24:27]
    v_mfma_f32_16x16x32_bf16 v[28:31], v[172:175], v[40:43], v[28:31]
    v_and_b32 v3, v3, v43
    s_waitcnt vmcnt(4)
    v_mfma_f32_16x16x32_bf16 v[16:19], v[176:179], v[44:47], v[16:19]
    v_mfma_f32_16x16x32_bf16 v[20:23], v[180:183], v[44:47], v[20:23]
    v_mfma_f32_16x16x32_bf16 v[24:27], v[184:187], v[44:47], v[24:27]
    v_mfma_f32_16x16x32_bf16 v[28:31], v[188:191], v[44:47], v[28:31]
    v_and_b32 v3, v3, v47
    s_waitcnt vmcnt(3)
    v_mfma_f32_16x16x32_bf16 v[16:19], v[192:195], v[48:51], v[16:19]
    v_mfma_f32_16x16x32_bf16 v[20:23], v[196:199], v[48:51], v[20:23]
    v_mfma_f32_16x16x32_bf16 v[24:27], v[200:203], v[48:51], v[24:27]
    v_mfma_f32_16x16x32_bf16 v[28:31], v[204:207], v[48:51], v[28:31]
    v_and_b32 v3, v3, v51
    s_waitcnt vmcnt(2)
    v_mfma_f32_16x16x32_bf16 v[16:19], v[208:211], v[52:55], v[16:19]
    v_mfma_f32_16x16x32_bf16 v[20:23], v[212:215], v[52:55], v[20:23]
    v_mfma_f32_16x16x32_bf16 v[24:27], v[216:219], v[52:55], v[24:27]
    v_mfma_f32_16x16x32_bf16 v[28:31], v[220:223], v[52:55], v[28:31]
    v_and_b32 v3, v3, v55
    s_waitcnt vmcnt(1)
    v_mfma_f32_16x16x32_bf16 v[16:19], v[224:227], v[56:59], v[16:19]
    v_mfma_f32_16x16x32_bf16 v[20:23], v[228:231], v[56:59], v[20:23]
    v_mfma_f32_16x16x32_bf16 v[24:27], v[232:235], v[56:59], v[24:27]
    v_mfma_f32_16x16x32_bf16 v[28:31], v[236:239], v[56:59], v[28:31]
    v_and_b32 v3, v3, v59
    s_waitcnt vmcnt(0)
    v_mfma_f32_16x16x32_bf16 v[16:19], v[240:243], v[60:63], v[16:19]
    v_mfma_f32_16x16x32_bf16 v[20:23], v[244:247], v[60:63], v[20:23]
    v_mfma_f32_16x16x32_bf16 v[24:27], v[248:251], v[60:63], v[24:27]
    v_mfma_f32_16x16x32_bf16 v[28:31], v[252:255], v[60:63], v[28:31]
    v_and_b32 v3, v3, v63
    s_branch Lg2
Lg1:
Lstop22:
    s_cbranch_execz Lstop30
    v_lshrrev_b32 v1, 1, v110
    s_mov_b32 s12, s72
    s_mov_b32 s13, s73
    s_mov_b32 s14, 896
    s_mov_b32 s15, 0x00020000
    buffer_load_dwordx2 v[80:81], v1, s[12:15], s42 offen offset:0
    buffer_load_dwordx2 v[82:83], v1, s[12:15], s42 offen offset:32
    buffer_load_dwordx2 v[84:85], v1, s[12:15], s42 offen offset:64
    buffer_load_dwordx2 v[86:87], v1, s[12:15], s42 offen offset:96
    buffer_load_dwordx4 v[88:91], v7, s[12:15], 0 offen
    ds_read_b64_tr_b16 v[128:129], v96 offset:0
    ds_read_b64_tr_b16 v[130:131], v100 offset:512
    ds_read_b64_tr_b16 v[132:133], v97 offset:0
    ds_read_b64_tr_b16 v[134:135], v101 offset:512
    ds_read_b64_tr_b16 v[136:137], v98 offset:0
    ds_read_b64_tr_b16 v[138:139], v102 offset:512
    ds_read_b64_tr_b16 v[140:141], v99 offset:0
    ds_read_b64_tr_b16 v[142:143], v103 offset:512
    v_cmp_ne_u32 vcc, s33, v116
    s_cbranch_vccnz Lclr1
Lclr_ok1:
    s_barrier
    s_waitcnt lgkmcnt(7)
    ds_read_b64_tr_b16 v[144:145], v96 offset:3584
    ds_read_b64_tr_b16 v[146:147], v100 offset:4096
    ds_read_b64_tr_b16 v[148:149], v97 offset:3584
    ds_read_b64_tr_b16 v[150:151], v101 offset:4096
    ds_read_b64_tr_b16 v[152:153], v98 offset:3584
    ds_read_b64_tr_b16 v[154:155], v102 offset:4096
    ds_read_b64_tr_b16 v[156:157], v99 offset:3584
    ds_read_b64_tr_b16 v[158:159], v103 offset:4096
    s_waitcnt lgkmcnt(7)
    ds_read_b64_tr_b16 v[160:161], v96 offset:7168
    ds_read_b64_tr_b16 v[162:163], v100 offset:7680
    ds_read_b64_tr_b16 v[164:165], v97 offset:7168
    ds_read_b64_tr_b16 v[166:167], v101 offset:7680
    ds_read_b64_tr_b16 v[168:169], v98 offset:7168
    ds_read_b64_tr_b16 v[170:171], v102 offset:7680
    ds_read_b64_tr_b16 v[172:173], v99 offset:7168
    ds_read_b64_tr_b16 v[174:175], v103 offset:7680
    s_waitcnt lgkmcnt(7)
    ds_read_b64_tr_b16 v[176:177], v96 offset:10752
    ds_read_b64_tr_b16 v[178:179], v100 offset:11264
    ds_read_b64_tr_b16 v[180:181], v97 offset:10752
    ds_read_b64_tr_b16 v[182:183], v101 offset:11264
    ds_read_b64_tr_b16 v[184:185], v98 offset:10752
    ds_read_b64_tr_b16 v[186:187], v102 offset:11264
    ds_read_b64_tr_b16 v[188:189], v99 offset:10752
    ds_read_b64_tr_b16 v[190:191], v103 offset:11264
    s_waitcnt lgkmcnt(7)
    ds_read_b64_tr_b16 v[192:193], v96 offset:14336
    ds_read_b64_tr_b16 v[194:195], v100 offset:14848
    ds_read_b64_tr_b16 v[196:197], v97 offset:14336
    ds_read_b64_tr_b16 v[198:199], v101 offset:14848
    ds_read_b64_tr_b16 v[200:201], v98 offset:14336
    ds_read_b64_tr_b16 v[202:203], v102 offset:14848
    ds_read_b64_tr_b16 v[204:205], v99 offset:14336
    ds_read_b64_tr_b16 v[206:207], v103 offset:14848
    s_waitcnt lgkmcnt(7)
    ds_read_b64_tr_b16 v[208:209], v96 offset:17920
    ds_read_b64_tr_b16 v[210:211], v100 offset:18432
    ds_read_b64_tr_b16 v[212:213], v97 offset:17920
    ds_read_b64_tr_b16 v[214:215], v101 offset:18432
    ds_read_b64_tr_b16 v[216:217], v98 offset:17920
    ds_read_b64_tr_b16 v[218:219], v102 offset:18432
    ds_read_b64_tr_b16 v[220:221], v99 offset:17920
    ds_read_b64_tr_b16 v[222:223], v103 offset:18432
    s_add_u32 s35, s6, 0
    buffer_load_dwordx4 v[32:35], v124, s[16:19], s35 offen sc1
    s_add_u32 s35, s6, 131072
    buffer_load_dwordx4 v[36:39], v124, s[16:19], s35 offen sc1
    s_add_u32 s35, s6, 262144
    buffer_load_dwordx4 v[40:43], v124, s[16:19], s35 offen sc1
    s_add_u32 s35, s6, 393216
    buffer_load_dwordx4 v[44:47], v124, s[16:19], s35 offen sc1
    s_waitcnt lgkmcnt(7)
    ds_read_b64_tr_b16 v[224:225], v96 offset:21504
    ds_read_b64_tr_b16 v[226:227], v100 offset:22016
    ds_read_b64_tr_b16 v[228:229], v97 offset:21504
    ds_read_b64_tr_b16 v[230:231], v101 offset:22016
    ds_read_b64_tr_b16 v[232:233], v98 offset:21504
    ds_read_b64_tr_b16 v[234:235], v102 offset:22016
    ds_read_b64_tr_b16 v[236:237], v99 offset:21504
    ds_read_b64_tr_b16 v[238:239], v103 offset:22016
    s_waitcnt lgkmcnt(7)
    ds_read_b64_tr_b16 v[240:241], v96 offset:25088
    ds_read_b64_tr_b16 v[242:243], v100 offset:25600
    ds_read_b64_tr_b16 v[244:245], v97 offset:25088
    ds_read_b64_tr_b16 v[246:247], v101 offset:25600
    ds_read_b64_tr_b16 v[248:249], v98 offset:25088
    ds_read_b64_tr_b16 v[250:251], v102 offset:25600
    ds_read_b64_tr_b16 v[252:253], v99 offset:25088
    ds_read_b64_tr_b16 v[254:255], v103 offset:25600
    s_add_u32 s35, s34, 524288
    buffer_load_dwordx4 v[48:51], v124, s[16:19], s35 offen sc1
    s_add_u32 s35, s34, 655360
    buffer_load_dwordx4 v[52:55], v124, s[16:19], s35 offen sc1
    s_add_u32 s35, s34, 786432
    buffer_load_dwordx4 v[56:59], v124, s[16:19], s35 offen sc1
    s_add_u32 s35, s34, 917504
    buffer_load_dwordx4 v[60:63], v124, s[16:19], s35 offen sc1
    s_waitcnt vmcnt(7)
    v_mfma_f32_16x16x32_bf16 v[16:19], v[128:131], v[32:35], 0
    v_mfma_f32_16x16x32_bf16 v[20:23], v[132:135], v[32:35], 0
    v_mfma_f32_16x16x32_bf16 v[24:27], v[136:139], v[32:35], 0
    v_mfma_f32_16x16x32_bf16 v[28:31], v[140:143], v[32:35], 0
    v_mov_b32 v76, 0
    s_waitcnt vmcnt(6)
    v_mfma_f32_16x16x32_bf16 v[16:19], v[144:147], v[36:39], v[16:19]
    v_mfma_f32_16x16x32_bf16 v[20:23], v[148:151], v[36:39], v[20:23]
    v_mfma_f32_16x16x32_bf16 v[24:27], v[152:155], v[36:39], v[24:27]
    v_mfma_f32_16x16x32_bf16 v[28:31], v[156:159], v[36:39], v[28:31]
    v_and_b32 v3, v35, v39
    v_mov_b32 v77, 0
    s_waitcnt vmcnt(5)
    v_mfma_f32_16x16x32_bf16 v[16:19], v[160:163], v[40:43], v[16:19]
    v_mfma_f32_16x16x32_bf16 v[20:23], v[164:167], v[40:43], v[20:23]
    v_mfma_f32_16x16x32_bf16 v[24:27], v[168:171], v[40:43], v[24:27]
    v_mfma_f32_16x16x32_bf16 v[28:31], v[172:175], v[40:43], v[28:31]
    v_and_b32 v3, v3, v43
    v_mov_b32 v78, 0
    s_waitcnt vmcnt(4)
    v_mfma_f32_16x16x32_bf16 v[16:19], v[176:179], v[44:47], v[16:19]
    v_mfma_f32_16x16x32_bf16 v[20:23], v[180:183], v[44:47], v[20:23]
    v_mfma_f32_16x16x32_bf16 v[24:27], v[184:187], v[44:47], v[24:27]
    v_mfma_f32_16x16x32_bf16 v[28:31], v[188:191], v[44:47], v[28:31]
    v_and_b32 v3, v3, v47
    v_mov_b32 v79, s33
    s_waitcnt vmcnt(3)
    v_mfma_f32_16x16x32_bf16 v[16:19], v[192:195], v[48:51], v[16:19]
    v_mfma_f32_16x16x32_bf16 v[20:23], v[196:199], v[48:51], v[20:23]
    v_mfma_f32_16x16x32_bf16 v[24:27], v[200:203], v[48:51], v[24:27]
    v_mfma_f32_16x16x32_bf16 v[28:31], v[204:207], v[48:51], v[28:31]
    v_and_b32 v3, v3, v51
    s_lshl_b32 s45, s42, 1
    s_add_u32 s45, s45, s49
    s_waitcnt vmcnt(2)
    v_mfma_f32_16x16x32_bf16 v[16:19], v[208:211], v[52:55], v[16:19]
    v_mfma_f32_16x16x32_bf16 v[20:23], v[212:215], v[52:55], v[20:23]
    v_mfma_f32_16x16x32_bf16 v[24:27], v[216:219], v[52:55], v[24:27]
    v_mfma_f32_16x16x32_bf16 v[28:31], v[220:223], v[52:55], v[28:31]
    v_and_b32 v3, v3, v55
    v_mov_b32 v72, 0
    s_waitcnt vmcnt(1) lgkmcnt(8)
    v_mfma_f32_16x16x32_bf16 v[16:19], v[224:227], v[56:59], v[16:19]
    v_mfma_f32_16x16x32_bf16 v[20:23], v[228:231], v[56:59], v[20:23]
    v_mfma_f32_16x16x32_bf16 v[24:27], v[232:235], v[56:59], v[24:27]
    v_mfma_f32_16x16x32_bf16 v[28:31], v[236:239], v[56:59], v[28:31]
    v_and_b32 v3, v3, v59
    s_waitcnt vmcnt(0) lgkmcnt(0)
    v_mfma_f32_16x16x32_bf16 v[16:19], v[240:243], v[60:63], v[16:19]
    v_mfma_f32_16x16x32_bf16 v[20:23], v[244:247], v[60:63], v[20:23]
    v_mfma_f32_16x16x32_bf16 v[24:27], v[248:251], v[60:63], v[24:27]
    v_mfma_f32_16x16x32_bf16 v[28:31], v[252:255], v[60:63], v[28:31]
    v_and_b32 v3, v3, v63
Lg2:
    v_cmp_le_i32 vcc, 0, v3
    s_cbranch_vccnz Lre
Lrex:
    s_cmp_eq_u32 s30, 1
    s_cbranch_scc1 Lsec
    ds_write_b128 v104, v[16:19] offset:0
    ds_write_b128 v104, v[20:23] offset:1024
    ds_write_b128 v104, v[24:27] offset:2048
    ds_write_b128 v104, v[28:31] offset:3072
    s_waitcnt lgkmcnt(0)
    s_barrier
    s_endpgm
Lsec:
    s_barrier
    ds_read_b128 v[32:35], v104 offset:0
    ds_read_b128 v[36:39], v104 offset:1024
    ds_read_b128 v[40:43], v104 offset:2048
    ds_read_b128 v[44:47], v104 offset:3072
    s_waitcnt lgkmcnt(3)
    v_pk_add_f32 v[32:33], v[32:33], v[16:17]
    v_pk_add_f32 v[34:35], v[34:35], v[18:19]
    v_cvt_pk_bf16_f32 v128, v32, v33
Lstop23:
    s_cbranch_execz Ltour_ret
    v_cvt_pk_bf16_f32 v129, v34, v35
    v_dot2c_f32_bf16 v76, s57, v128
    v_dot2c_f32_bf16 v77, v128, v128
    v_dot2c_f32_bf16 v78, v80, v128
    v_dot2c_f32_bf16 v76, s57, v129
    v_dot2c_f32_bf16 v77, v129, v129
    v_dot2c_f32_bf16 v78, v81, v129
    s_waitcnt lgkmcnt(2)
    v_pk_add_f32 v[36:37], v[36:37], v[20:21]
    v_pk_add_f32 v[38:39], v[38:39], v[22:23]
    v_cvt_pk_bf16_f32 v132, v36, v37
    v_cvt_pk_bf16_f32 v133, v38, v39
    v_dot2c_f32_bf16 v76, s57, v132
    v_dot2c_f32_bf16 v77, v132, v132
    v_dot2c_f32_bf16 v78, v82, v132
    v_dot2c_f32_bf16 v76, s57, v133
    v_dot2c_f32_bf16 v77, v133, v133
    v_dot2c_f32_bf16 v78, v83, v133
    s_waitcnt lgkmcnt(1)
    v_pk_add_f32 v[40:41], v[40:41], v[24:25]
    v_pk_add_f32 v[42:43], v[42:43], v[26:27]
    v_cvt_pk_bf16_f32 v136, v40, v41
    v_cvt_pk_bf16_f32 v137, v42, v43
    v_dot2c_f32_bf16 v76, s57, v136
    v_dot2c_f32_bf16 v77, v136, v136
    v_dot2c_f32_bf16 v78, v84, v136
    v_dot2c_f32_bf16 v76, s57, v137
    v_dot2c_f32_bf16 v77, v137, v137
    v_dot2c_f32_bf16 v78, v85, v137
    s_waitcnt lgkmcnt(0)
    v_pk_add_f32 v[44:45], v[44:45], v[28:29]
    v_pk_add_f32 v[46:47], v[46:47], v[30:31]
    v_cvt_pk_bf16_f32 v140, v44, v45
    v_cvt_pk_bf16_f32 v141, v46, v47
    v_dot2c_f32_bf16 v76, s57, v140
    v_dot2c_f32_bf16 v77, v140, v140
    v_dot2c_f32_bf16 v78, v86, v140
    v_dot2c_f32_bf16 v76, s57, v141
    v_dot2c_f32_bf16 v77, v141, v141
    v_dot2c_f32_bf16 v78, v87, v141
    s_nop 0
    v_mov_b32 v64, v76
    v_mov_b32 v65, v77
    v_mov_b32 v66, v78
    v_permlane32_swap_b32 v64, v76
    v_permlane32_swap_b32 v65, v77
    v_permlane32_swap_b32 v66, v78
    v_add_f32 v76, v64, v76
    v_add_f32 v77, v65, v77
    v_add_f32 v78, v66, v78
    v_mov_b32 v64, v76
    v_mov_b32 v65, v77
    v_mov_b32 v66, v78
    v_permlane16_swap_b32 v64, v76
    v_permlane16_swap_b32 v65, v77
    v_permlane16_swap_b32 v66, v78
    v_add_f32 v76, v64, v76
    v_add_f32 v77, v65, v77
    v_add_f32 v78, v66, v78
    s_mov_b64 exec, 0xffff
    s_cmp_eq_u32 s7, 0
    s_cbranch_scc1 Lglob_12
    buffer_store_dwordx4 v[76:79], v7, s[16:19], s45 offen
Ljoin_13:
    s_mov_b64 exec, -1
    buffer_load_dwordx4 v[16:19], v7, s[16:19], s49 offen sc1
    buffer_load_dwordx4 v[20:23], v107, s[16:19], s49 offen offset:1024 sc1
    v_dot2c_f32_bf16 v72, s57, v88
    v_dot2c_f32_bf16 v72, s57, v89
    v_dot2c_f32_bf16 v72, s57, v90
    v_dot2c_f32_bf16 v72, s57, v91
    s_nop 2
    v_add_f32_dpp v72, v72, v72 row_ror:1 row_mask:0xf bank_mask:0xf
    v_lshlrev_b32 v160, 16, v128
    v_and_b32 v161, 0xffff0000, v128
    v_lshlrev_b32 v162, 16, v129
    v_and_b32 v163, 0xffff0000, v129
    v_add_f32_dpp v72, v72, v72 row_ror:2 row_mask:0xf bank_mask:0xf
    v_lshlrev_b32 v164, 16, v132
    v_and_b32 v165, 0xffff0000, v132
    v_lshlrev_b32 v166, 16, v133
    v_and_b32 v167, 0xffff0000, v133
    v_add_f32_dpp v72, v72, v72 row_ror:4 row_mask:0xf bank_mask:0xf
    v_lshlrev_b32 v168, 16, v136
    v_and_b32 v169, 0xffff0000, v136
    v_lshlrev_b32 v170, 16, v137
    v_and_b32 v171, 0xffff0000, v137
    v_add_f32_dpp v72, v72, v72 row_ror:8 row_mask:0xf bank_mask:0xf
    v_lshlrev_b32 v172, 16, v140
    v_and_b32 v173, 0xffff0000, v140
    v_lshlrev_b32 v174, 16, v141
    v_and_b32 v175, 0xffff0000, v141
    v_mov_b32 v64, v72
    s_nop 1
    v_permlane32_swap_b32 v64, v72
    v_add_f32 v72, v64, v72
    v_mov_b32 v64, v72
    s_nop 1
    v_permlane16_swap_b32 v64, v72
    v_add_f32 v72, v64, v72
    v_mov_b32 v130, s33
    v_mov_b32 v146, s33
    v_mov_b32 v134, s33
    v_mov_b32 v150, s33
    v_mov_b32 v138, s33
    v_mov_b32 v154, s33
    v_mov_b32 v142, s33
    v_mov_b32 v158, s33
    s_mov_b32 s24, s80
    s_mov_b32 s25, s81
    s_mov_b32 s26, 1835008
    s_mov_b32 s27, 0x00020000
    v_mov_b32 v26, s33
    v_add_u32 v5, 4096, v110
    s_lshl_b32 s41, s53, 7
    s_add_u32 s41, s41, 4096
    s_branch Lst1
Lst:
    buffer_load_dwordx4 v[16:19], v7, s[16:19], s49 offen sc1
    buffer_load_dwordx4 v[20:23], v107, s[16:19], s49 offen offset:1024 sc1
    s_sub_u32 s58, s58, 1
    s_bitcmp1_b32 s58, 31
    s_cbranch_scc1 Lstx
Lst1:
    s_waitcnt vmcnt(0)
    v_cmp_ne_u32 s[46:47], s33, v23
    v_cmp_ne_u32 vcc, s33, v19
    v_add_f32 v16, v16, v20
    v_add_f32 v17, v17, v21
    v_add_f32 v18, v18, v22
    s_and_b32 s47, s47, 0xffff
    s_or_b64 vcc, vcc, s[46:47]
    s_cbranch_scc1 Lst
Lstx:
    v_mov_b32 v64, v16
    v_mov_b32 v65, v17
    v_mov_b32 v66, v18
    v_permlane32_swap_b32 v64, v16
    v_permlane32_swap_b32 v65, v17
    v_permlane32_swap_b32 v66, v18
    v_add_f32 v16, v64, v16
    v_add_f32 v17, v65, v17
    v_add_f32 v18, v66, v18
    v_mov_b32 v64, v16
    v_mov_b32 v65, v17
    v_mov_b32 v66, v18
    v_permlane16_swap_b32 v64, v16
    v_permlane16_swap_b32 v65, v17
    v_permlane16_swap_b32 v66, v18
    v_add_f32 v16, v64, v16
    v_add_f32 v17, v65, v17
    v_add_f32 v18, v66, v18
    v_mul_f32 v16, 0x3b124925, v16
    v_mul_f32 v17, 0x3b124925, v17
    v_fma_f32 v17, -v16, v16, v17
    v_max_f32 v17, 0, v17
    v_cvt_pk_bf16_f32 v19, v17, -v16
    v_lshlrev_b32 v17, 16, v19
    v_add_f32 v17, 0x3727c5ac, v17
    v_cvt_pk_bf16_f32 v17, v17, v17
    v_lshlrev_b32 v17, 16, v17
    v_sqrt_f32 v17, v17
    v_and_b32 v20, 0xffff0000, v19
    v_cvt_pk_bf16_f32 v17, v17, v17
    v_lshlrev_b32 v17, 16, v17
    v_rcp_f32 v22, v17
    v_fma_f32 v131, v20, v72, v18
    v_mul_f32 v131, v131, v22
    v_ashrrev_i32 v3, 31, v131
    v_bitop3_b32 v3, v3, v131, s82 bitop3:0x36
    v_and_or_b32 v73, v3, s83, v109
    ds_write_b32 v108, v73
    v_pk_add_f32 v[176:177], v[160:161], v[20:21] op_sel_hi:[1,0]
    v_pk_add_f32 v[178:179], v[162:163], v[20:21] op_sel_hi:[1,0]
    v_pk_add_f32 v[180:181], v[164:165], v[20:21] op_sel_hi:[1,0]
    v_pk_add_f32 v[182:183], v[166:167], v[20:21] op_sel_hi:[1,0]
    v_pk_add_f32 v[184:185], v[168:169], v[20:21] op_sel_hi:[1,0]
    v_pk_add_f32 v[186:187], v[170:171], v[20:21] op_sel_hi:[1,0]
    v_pk_add_f32 v[188:189], v[172:173], v[20:21] op_sel_hi:[1,0]
    v_pk_add_f32 v[190:191], v[174:175], v[20:21] op_sel_hi:[1,0]
    v_cvt_pk_bf16_f32 v32, v176, v177
    v_cvt_pk_bf16_f32 v33, v178, v179
    v_cvt_pk_bf16_f32 v34, v180, v181
    v_cvt_pk_bf16_f32 v35, v182, v183
    v_cvt_pk_bf16_f32 v36, v184, v185
    v_cvt_pk_bf16_f32 v37, v186, v187
    v_cvt_pk_bf16_f32 v38, v188, v189
    v_cvt_pk_bf16_f32 v39, v190, v191
    s_waitcnt lgkmcnt(0)
    s_barrier
    ds_read_b128 v[68:71], v111
    v_lshlrev_b32 v176, 16, v32
    v_and_b32 v177, 0xffff0000, v32
    v_lshlrev_b32 v178, 16, v33
    v_and_b32 v179, 0xffff0000, v33
    v_lshlrev_b32 v180, 16, v34
    v_and_b32 v181, 0xffff0000, v34
    v_lshlrev_b32 v182, 16, v35
    v_and_b32 v183, 0xffff0000, v35
    v_lshlrev_b32 v184, 16, v36
    v_and_b32 v185, 0xffff0000, v36
    v_lshlrev_b32 v186, 16, v37
    v_and_b32 v187, 0xffff0000, v37
    v_lshlrev_b32 v188, 16, v38
    v_and_b32 v189, 0xffff0000, v38
    v_lshlrev_b32 v190, 16, v39
    v_and_b32 v191, 0xffff0000, v39
    v_pk_mul_f32 v[176:177], v[176:177], v[22:23] op_sel_hi:[1,0]
    v_pk_mul_f32 v[178:179], v[178:179], v[22:23] op_sel_hi:[1,0]
    v_pk_mul_f32 v[180:181], v[180:181], v[22:23] op_sel_hi:[1,0]
    v_pk_mul_f32 v[182:183], v[182:183], v[22:23] op_sel_hi:[1,0]
    v_pk_mul_f32 v[184:185], v[184:185], v[22:23] op_sel_hi:[1,0]
    v_pk_mul_f32 v[186:187], v[186:187], v[22:23] op_sel_hi:[1,0]
    v_pk_mul_f32 v[188:189], v[188:189], v[22:23] op_sel_hi:[1,0]
    v_pk_mul_f32 v[190:191], v[190:191], v[22:23] op_sel_hi:[1,0]
    s_or_b32 s35, s54, s29
    s_waitcnt lgkmcnt(0)
    v_max3_u32 v27, v68, v69, v70
    v_med3_u32 v25, v68, v69, v70
    v_max_u32 v24, v27, v71
    v_med3_u32 v25, v27, v25, v71
    v_cvt_pk_bf16_f32 v144, v176, v177
Lstop24:
    s_cbranch_execz Ltour_ret
    v_min_u32_dpp v27, v24, v24 row_ror:1 row_mask:0xf bank_mask:0xf
    v_max_u32_dpp v24, v24, v24 row_ror:1 row_mask:0xf bank_mask:0xf
    v_max_u32_dpp v25, v25, v25 row_ror:1 row_mask:0xf bank_mask:0xf
    v_max_u32 v25, v25, v27
    v_cvt_pk_bf16_f32 v145, v178, v179
    v_min_u32_dpp v27, v24, v24 row_ror:2 row_mask:0xf bank_mask:0xf
    v_max_u32_dpp v24, v24, v24 row_ror:2 row_mask:0xf bank_mask:0xf
    v_max_u32_dpp v25, v25, v25 row_ror:2 row_mask:0xf bank_mask:0xf
    v_max_u32 v25, v25, v27
    v_cvt_pk_bf16_f32 v148, v180, v181
    v_min_u32_dpp v27, v24, v24 row_ror:4 row_mask:0xf bank_mask:0xf
    v_max_u32_dpp v24, v24, v24 row_ror:4 row_mask:0xf bank_mask:0xf
    v_max_u32_dpp v25, v25, v25 row_ror:4 row_mask:0xf bank_mask:0xf
    v_max_u32 v25, v25, v27
    v_cvt_pk_bf16_f32 v149, v182, v183
    v_min_u32_dpp v27, v24, v24 row_ror:8 row_mask:0xf bank_mask:0xf
    v_max_u32_dpp v24, v24, v24 row_ror:8 row_mask:0xf bank_mask:0xf
    v_max_u32_dpp v25, v25, v25 row_ror:8 row_mask:0xf bank_mask:0xf
    v_max_u32 v25, v25, v27
    s_cbranch_scc1 Lnosc
    s_mov_b64 exec, 1
    buffer_store_dwordx3 v[24:26], v120, s[16:19], s41 offen sc1
    s_mov_b64 exec, -1
Lnosc:
    v_cmp_le_u32 s[48:49], v25, v73
    v_cmp_eq_u32 vcc, v25, v73
    v_cvt_pk_bf16_f32 v152, v184, v185
    v_cvt_pk_bf16_f32 v153, v186, v187
    v_cvt_pk_bf16_f32 v156, v188, v189
    v_cvt_pk_bf16_f32 v157, v190, v191
    s_cmp_eq_u64 s[48:49], 0
    s_cbranch_scc1 Lnocand
    v_cndmask_b32 v3, v110, v5, vcc
    s_mov_b64 exec, s[48:49]
    buffer_store_dwordx3 v[144:146], v3, s[16:19], s50 offen offset:0 sc1
    buffer_store_dwordx3 v[148:150], v3, s[16:19], s50 offen offset:64 sc1
    buffer_store_dwordx3 v[152:154], v3, s[16:19], s50 offen offset:128 sc1
    buffer_store_dwordx3 v[156:158], v3, s[16:19], s50 offen offset:192 sc1
    v_mov_b32 v135, v131
    v_mov_b32 v139, v131
    v_mov_b32 v143, v131
    buffer_store_dwordx4 v[128:131], v3, s[16:19], s50 offen offset:2048 sc1
    buffer_store_dwordx4 v[132:135], v3, s[16:19], s50 offen offset:2112 sc1
    buffer_store_dwordx4 v[136:139], v3, s[16:19], s50 offen offset:2176 sc1
    buffer_store_dwordx4 v[140:143], v3, s[16:19], s50 offen offset:2240 sc1
    s_mov_b64 exec, -1
Lnocand:
    v_lshlrev_b32 v176, 16, v144
    v_and_b32 v177, 0xffff0000, v144
    v_lshlrev_b32 v178, 16, v145
    v_and_b32 v179, 0xffff0000, v145
    v_lshlrev_b32 v180, 16, v148
    v_and_b32 v181, 0xffff0000, v148
    v_lshlrev_b32 v182, 16, v149
    v_and_b32 v183, 0xffff0000, v149
    v_lshlrev_b32 v184, 16, v152
    v_and_b32 v185, 0xffff0000, v152
    v_lshlrev_b32 v186, 16, v153
    v_and_b32 v187, 0xffff0000, v153
    v_lshlrev_b32 v188, 16, v156
    v_and_b32 v189, 0xffff0000, v156
    v_lshlrev_b32 v190, 16, v157
    v_and_b32 v191, 0xffff0000, v157
    v_pk_add_f32 v[176:177], v[160:161], v[176:177]
    v_pk_add_f32 v[178:179], v[162:163], v[178:179]
    v_pk_add_f32 v[180:181], v[164:165], v[180:181]
    v_pk_add_f32 v[182:183], v[166:167], v[182:183]
    v_pk_add_f32 v[184:185], v[168:169], v[184:185]
    v_pk_add_f32 v[186:187], v[170:171], v[186:187]
    v_pk_add_f32 v[188:189], v[172:173], v[188:189]
    v_pk_add_f32 v[190:191], v[174:175], v[190:191]
    v_cvt_pk_bf16_f32 v32, v176, v177
    v_cvt_pk_bf16_f32 v33, v178, v179
    v_cvt_pk_bf16_f32 v34, v180, v181
    v_cvt_pk_bf16_f32 v35, v182, v183
    v_cvt_pk_bf16_f32 v36, v184, v185
    v_cvt_pk_bf16_f32 v37, v186, v187
    v_cvt_pk_bf16_f32 v38, v188, v189
    v_cvt_pk_bf16_f32 v39, v190, v191
    ds_write_b64 v106, v[32:33] offset:0
    ds_write_b64 v106, v[34:35] offset:32
    ds_write_b64 v106, v[36:37] offset:64
    ds_write_b64 v106, v[38:39] offset:96
    v_lshrrev_b32 v3, 3, v2
    s_lshl_b32 s35, s29, 6
    s_add_u32 s35, s35, 156928
    v_lshl_add_u32 v3, v3, 2, s35
    ds_read_b128 v[192:195], v105
    ds_read_b128 v[196:199], v105 offset:1152
    ds_read2_b32 v[74:75], v3 offset1:8
    s_waitcnt vmcnt(0)
    s_barrier
    s_waitcnt lgkmcnt(0)
    v_cmp_gt_u32 s[44:45], v25, v74
    v_cmp_gt_u32 s[46:47], v25, v75
    s_mov_b64 exec, s[44:45]
    buffer_store_dwordx4 v[192:195], v127, s[24:27], s42 offen sc1
    s_mov_b64 exec, s[46:47]
    buffer_store_dwordx4 v[196:199], v127, s[24:27], s43 offen sc1
    s_mov_b64 exec, -1
    s_cmp_eq_u64 s[48:49], 0
    s_cbranch_scc1 Lnocs
    s_movk_i32 s38, 2048
    s_mov_b64 exec, 1
Lsel:
    buffer_load_dwordx3 v[28:30], v120, s[16:19], s38 offen sc1
    s_sub_u32 s58, s58, 1
    s_bitcmp1_b32 s58, 31
    s_cbranch_scc1 Lselx
    s_waitcnt vmcnt(0)
    v_cmp_ne_u32 vcc, s33, v30
    s_cbranch_vccnz Lsel
Lselx:
    s_waitcnt vmcnt(0)
    v_readfirstlane_b32 s35, v29
    s_mov_b64 exec, -1
    s_nop 0
    v_cmp_gt_u32 vcc, s35, v74
    s_andn2_b64 vcc, vcc, s[44:45]
    s_cbranch_scc0 Lnocs0
    s_mov_b64 exec, vcc
    buffer_store_dwordx4 v[192:195], v127, s[24:27], s42 offen sc1
    s_mov_b64 exec, -1
Lnocs0:
    v_cmp_gt_u32 vcc, s35, v75
    s_andn2_b64 vcc, vcc, s[46:47]
    s_cbranch_scc0 Lnocs1
    s_mov_b64 exec, vcc
    buffer_store_dwordx4 v[196:199], v127, s[24:27], s43 offen sc1
    s_mov_b64 exec, -1
Lnocs1:
Lnocs:
    s_endpgm
Lffn:
Lstop25:
    s_cbranch_execz Ltour_ret
    s_cmp_ge_u32 s55, 28
    s_cbranch_scc1 Lidle
    s_mov_b32 s8, s76
    s_mov_b32 s9, s77
    s_mov_b32 s10, 1605632
    s_mov_b32 s11, 0x00020000
    s_mov_b32 s12, s78
    s_mov_b32 s13, s79
    s_mov_b32 s14, 1605632
    s_mov_b32 s15, 0x00020000
    s_mov_b32 s20, s74
    s_mov_b32 s21, s75
    s_mov_b32 s22, 1605632
    s_mov_b32 s23, 0x00020000
    s_lshl_b32 s40, s55, 7
    s_mul_i32 s35, s28, 28672
    s_add_u32 s40, s40, s35
    s_lshl_b32 s41, s28, 10
    s_and_b32 s36, s28, 1
    s_lshl_b32 s36, s36, 5
    v_and_b32 v3, 16, v2
    v_and_b32 v4, 0x70, v7
    v_xor_b32 v3, v3, v4
    v_xor_b32 v3, s36, v3
    v_lshrrev_b32 v4, 3, v2
    v_mul_u32_u24 v4, 3584, v4
    v_add_u32 v5, v3, v4
    v_xor_b32 v6, 64, v5
    s_barrier
    s_add_u32 m0, s41, 98304
    s_add_u32 s35, s40, 0
    buffer_load_dwordx4 v5, s[20:23], s35 offen lds
Lstop26:
    s_cbranch_execz Ltour_ret
    s_add_u32 m0, s41, 32768
    s_nop 0
    buffer_load_dwordx4 v6, s[8:11], s35 offen lds
    s_add_u32 m0, s41, 106496
    s_add_u32 s35, s40, 229376
    buffer_load_dwordx4 v5, s[20:23], s35 offen lds
    s_add_u32 m0, s41, 40960
    s_nop 0
    buffer_load_dwordx4 v6, s[8:11], s35 offen lds
    s_add_u32 m0, s41, 114688
    s_add_u32 s35, s40, 458752
    buffer_load_dwordx4 v5, s[20:23], s35 offen lds
    s_add_u32 m0, s41, 49152
    s_nop 0
    buffer_load_dwordx4 v6, s[8:11], s35 offen lds
    s_add_u32 m0, s41, 122880
    s_add_u32 s35, s40, 688128
    buffer_load_dwordx4 v5, s[20:23], s35 offen lds
    s_add_u32 m0, s41, 57344
    s_nop 0
    buffer_load_dwordx4 v6, s[8:11], s35 offen lds
    s_add_u32 m0, s41, 131072
    s_add_u32 s35, s40, 917504
    buffer_load_dwordx4 v5, s[20:23], s35 offen lds
    s_add_u32 m0, s41, 65536
    s_nop 0
    buffer_load_dwordx4 v6, s[8:11], s35 offen lds
    s_add_u32 m0, s41, 139264
    s_add_u32 s35, s40, 1146880
    buffer_load_dwordx4 v5, s[20:23], s35 offen lds
    s_add_u32 m0, s41, 73728
    s_nop 0
    buffer_load_dwordx4 v6, s[8:11], s35 offen lds
    s_add_u32 m0, s41, 147456
    s_add_u32 s35, s40, 1376256
    buffer_load_dwordx4 v5, s[20:23], s35 offen lds
    s_add_u32 m0, s41, 81920
    s_nop 0
    buffer_load_dwordx4 v6, s[8:11], s35 offen lds
    v_lshrrev_b32 v3, 3, v2
    v_and_b32 v4, 7, v2
    v_mul_u32_u24 v3, 896, v3
    v_lshl_add_u32 v3, v4, 4, v3
    s_mul_i32 s40, s55, 57344
    s_min_u32 s35, s28, 6
    s_lshl_b32 s35, s35, 7
    s_add_u32 s40, s40, s35
    s_add_u32 s35, s40, 0
    buffer_load_dwordx4 v[64:67], v3, s[12:15], s35 offen
    s_add_u32 s35, s40, 7168
    buffer_load_dwordx4 v[68:71], v3, s[12:15], s35 offen
    s_add_u32 s35, s40, 14336
    buffer_load_dwordx4 v[72:75], v3, s[12:15], s35 offen
    s_add_u32 s35, s40, 21504
    buffer_load_dwordx4 v[76:79], v3, s[12:15], s35 offen
    s_add_u32 s35, s40, 28672
    buffer_load_dwordx4 v[80:83], v3, s[12:15], s35 offen
    s_add_u32 s35, s40, 35840
    buffer_load_dwordx4 v[84:87], v3, s[12:15], s35 offen
    s_add_u32 s35, s40, 43008
    buffer_load_dwordx4 v[88:91], v3, s[12:15], s35 offen
    s_add_u32 s35, s40, 50176
    buffer_load_dwordx4 v[92:95], v3, s[12:15], s35 offen
    s_mov_b32 s24, s80
    s_mov_b32 s25, s81
    s_mov_b32 s26, 1835008
    s_mov_b32 s27, 0x00020000
    v_lshrrev_b32 v3, 4, v2
    v_bfe_u32 v4, v2, 2, 2
    v_lshl_add_u32 v5, v3, 3, v4
    v_lshlrev_b32 v5, 7, v5
    v_lshrrev_b32 v4, 1, v4
    v_and_b32 v1, 1, v3
    v_lshl_add_u32 v4, v1, 1, v4
    v_and_b32 v6, 3, v2
    s_lshl_b32 s41, s28, 12
    v_lshl_add_u32 v9, v6, 3, v5
    v_lshl_add_u32 v9, v4, 5, v9
    v_add_u32 v9, s41, v9
    v_lshlrev_b32 v10, 5, v1
    v_xor_b32 v10, v10, v7
    v_add_u32 v10, s41, v10
    v_xor_b32 v14, 64, v10
    v_bfe_u32 v15, v2, 1, 1
    v_lshl_add_u32 v4, v15, 2, v4
    v_xor_b32 v4, s28, v4
    v_and_b32 v6, 1, v2
    v_lshl_add_u32 v8, v6, 3, v5
    v_lshl_add_u32 v8, v4, 4, v8
    v_mul_u32_u24 v15, 65536, v15
    v_sub_u32 v8, v8, v15
    v_add_u32 v8, 98304, v8
    v_bfe_u32 v15, v2, 2, 1
    v_lshl_add_u32 v15, v15, 1, v6
    v_mul_u32_u24 v11, 448, v15
    v_lshl_add_u32 v11, v3, 4, v11
    v_add_u32 v11, 157696, v11
    v_mul_u32_u24 v44, 0xaaaa, v6
    v_add_u32 v44, 0x4444, v44
    v_bfe_u32 v15, v2, 1, 1
    v_lshl_add_u32 v13, v1, 1, v15
    v_lshlrev_b32 v13, 6, v13
    v_lshl_add_u32 v13, v6, 1, v13
    v_and_b32 v15, 4, v2
    s_lshl_b32 s35, s28, 3
    s_add_u32 s35, s35, 159744
    v_add3_u32 v13, v13, v15, s35
    v_and_b32 v15, 3, v2
    v_lshlrev_b32 v15, 6, v15
    v_lshl_add_u32 v15, v3, 4, v15
    v_add_u32 v15, 159744, v15
    v_mov_b32 v52, 160000
    v_mov_b32 v53, v52
    v_mov_b32 v54, v52
    v_mov_b32 v55, v52
    ds_write_b128 v52, v[120:123]
    s_mov_b32 exec_lo, 0x000f000f
    s_mov_b32 exec_hi, 0x000f000f
    v_mov_b32 v52, v15
    s_lshl_b64 exec, exec, 4
    v_mov_b32 v53, v15
    s_lshl_b64 exec, exec, 4
    v_mov_b32 v54, v15
    s_lshl_b64 exec, exec, 4
    v_mov_b32 v55, v15
    s_mov_b64 exec, -1
    v_mov_b32 v32, 0
    v_mov_b32 v33, 0
    v_mov_b32 v34, 0
    v_mov_b32 v35, 0
    v_mov_b32 v36, 0
    v_mov_b32 v37, 0
    v_mov_b32 v38, 0
    v_mov_b32 v39, 0
    v_mov_b32 v49, s33
    v_mov_b32 v51, s33
    v_xor_b32 v16, 32, v9
    v_xor_b32 v17, 64, v9
    v_xor_b32 v18, 96, v9
    s_mul_i32 s35, s28, 56
    s_add_u32 s35, s35, s55
    s_lshl_b32 s35, s35, 8
    s_add_u32 s42, s35, 32768
    s_add_u32 s43, s42, 100352
    v_lshrrev_b32 v15, 5, v2
    v_mul_u32_u24 v15, 6912, v15
    v_lshl_add_u32 v15, v2, 3, v15
    s_waitcnt vmcnt(8)
    s_barrier
    ds_read_b64_tr_b16 v[128:129], v8 offset:0
    ds_read_b64_tr_b16 v[130:131], v8 offset:512
    ds_read_b64_tr_b16 v[132:133], v8 offset:4096
    ds_read_b64_tr_b16 v[134:135], v8 offset:4608
    ds_read_b64_tr_b16 v[136:137], v8 offset:8192
    ds_read_b64_tr_b16 v[138:139], v8 offset:8704
    ds_read_b64_tr_b16 v[140:141], v8 offset:12288
    ds_read_b64_tr_b16 v[142:143], v8 offset:12800
    s_waitcnt lgkmcnt(4)
    ds_read_b64_tr_b16 v[144:145], v8 offset:16384
    ds_read_b64_tr_b16 v[146:147], v8 offset:16896
    ds_read_b64_tr_b16 v[148:149], v8 offset:20480
    ds_read_b64_tr_b16 v[150:151], v8 offset:20992
    ds_read_b64_tr_b16 v[152:153], v8 offset:24576
    ds_read_b64_tr_b16 v[154:155], v8 offset:25088
    ds_read_b64_tr_b16 v[156:157], v8 offset:28672
    ds_read_b64_tr_b16 v[158:159], v8 offset:29184
    s_waitcnt lgkmcnt(4)
    ds_read_b64_tr_b16 v[160:161], v8 offset:32768
    ds_read_b64_tr_b16 v[162:163], v8 offset:33280
    ds_read_b64_tr_b16 v[164:165], v8 offset:36864
    ds_read_b64_tr_b16 v[166:167], v8 offset:37376
    ds_read_b64_tr_b16 v[168:169], v8 offset:40960
    ds_read_b64_tr_b16 v[170:171], v8 offset:41472
    ds_read_b64_tr_b16 v[172:173], v8 offset:45056
    ds_read_b64_tr_b16 v[174:175], v8 offset:45568
    s_waitcnt lgkmcnt(4)
    ds_read_b64_tr_b16 v[176:177], v8 offset:49152
    ds_read_b64_tr_b16 v[178:179], v8 offset:49664
    ds_read_b64_tr_b16 v[180:181], v8 offset:53248
    ds_read_b64_tr_b16 v[182:183], v8 offset:53760
    s_cmp_eq_u32 s28, 7
    s_cbranch_scc1 Lf1
    s_waitcnt vmcnt(4) lgkmcnt(0)
    ds_write_b128 v10, v[64:67] offset:0
    ds_write_b128 v14, v[68:71] offset:1024
    ds_write_b128 v10, v[72:75] offset:2048
Lstop27:
    s_cbranch_execz Ltour_ret
    ds_write_b128 v14, v[76:79] offset:3072
    ds_read_b64_tr_b16 v[192:193], v9 offset:0
    ds_read_b64_tr_b16 v[194:195], v9 offset:512
    ds_read_b64_tr_b16 v[200:201], v16 offset:0
    ds_read_b64_tr_b16 v[202:203], v16 offset:512
    ds_read_b64_tr_b16 v[208:209], v17 offset:0
    ds_read_b64_tr_b16 v[210:211], v17 offset:512
    ds_read_b64_tr_b16 v[216:217], v18 offset:0
    ds_read_b64_tr_b16 v[218:219], v18 offset:512
    s_waitcnt vmcnt(0) lgkmcnt(0)
    ds_write_b128 v10, v[80:83] offset:0
    ds_write_b128 v14, v[84:87] offset:1024
    ds_write_b128 v10, v[88:91] offset:2048
    ds_write_b128 v14, v[92:95] offset:3072
    ds_read_b64_tr_b16 v[196:197], v9 offset:0
    ds_read_b64_tr_b16 v[198:199], v9 offset:512
    ds_read_b64_tr_b16 v[204:205], v16 offset:0
    ds_read_b64_tr_b16 v[206:207], v16 offset:512
    ds_read_b64_tr_b16 v[212:213], v17 offset:0
    ds_read_b64_tr_b16 v[214:215], v17 offset:512
    ds_read_b64_tr_b16 v[220:221], v18 offset:0
    ds_read_b64_tr_b16 v[222:223], v18 offset:512
    s_branch Lf2
Lf1:
    v_and_b32 v3, 31, v2
    v_lshlrev_b32 v3, 7, v3
    v_min_u32 v5, 55, v2
    v_lshlrev_b32 v4, 2, v5
    v_add_u32 v4, 157696, v4
    v_add_u32 v12, 896, v4
    v_lshlrev_b32 v5, 4, v5
    s_cmp_ge_u32 s55, 14
    s_cselect_b32 s36, 14, 0
    s_cselect_b32 s37, 896, 0
    s_sub_u32 s36, s55, s36
    s_lshl_b32 s43, s36, 6
    s_lshr_b32 s35, s43, 1
    s_add_u32 s37, s37, s35
    s_add_u32 s37, s37, 157696
    s_mul_i32 s41, s55, 7168
    s_add_u32 s41, s41, 32768
    s_add_u32 s42, s41, 4096
    v_and_b32 v9, 15, v2
    v_lshlrev_b32 v10, 2, v9
    v_lshrrev_b32 v9, 1, v9
    v_and_b32 v6, 1, v2
    v_mul_u32_u24 v14, 448, v6
    v_lshl_add_u32 v14, v9, 2, v14
    v_add_u32 v14, s37, v14
    s_lshl_b32 s36, s36, 7
    v_lshl_add_u32 v9, v9, 4, s36
    v_cmp_eq_u32 s[44:45], 1, v6
    s_mov_b32 s59, 0
    s_mov_b32 s60, 0
    s_movk_i32 s47, 4096
    s_movk_i32 s70, 8
    s_mov_b32 s48, -1
    s_mov_b32 s49, 0
Lfs:
    s_mov_b64 exec, s[48:49]
    buffer_load_dwordx3 v[60:62], v3, s[16:19], s47 offen sc1
    s_sub_u32 s58, s58, 1
    s_bitcmp1_b32 s58, 31
    s_cbranch_scc1 Lfs2
Lfs0:
    s_waitcnt vmcnt(0)
    v_cmp_ne_u32 s[48:49], s33, v62
    s_bcnt1_i32_b32 s35, s48
    s_cmp_gt_i32 s35, s70
    s_cbranch_scc1 Lfs
    s_mov_b32 exec_lo, -1
    s_sub_u32 s70, s35, 1
    v_cndmask_b32 v56, v60, 0, s[48:49]
    v_cndmask_b32 v57, v61, 0, s[48:49]
    v_cmp_lt_u32 vcc, s60, v56
    v_cmp_ne_u32 s[68:69], s59, v56
    s_and_b64 vcc, vcc, s[68:69]
    s_cbranch_scc1 Lfnew
    s_cmp_lg_u32 s48, 0
    s_cbranch_scc1 Lfs
Lfs2:
    s_mov_b64 exec, -1
Lf2:
    s_waitcnt lgkmcnt(0)
    s_barrier
    ds_read_b128 v[64:67], v11 offset:0
    ds_read_b128 v[68:71], v11 offset:64
    ds_read_b128 v[72:75], v11 offset:128
    ds_read_b128 v[76:79], v11 offset:192
    ds_read_b128 v[80:83], v11 offset:256
    ds_read_b128 v[84:87], v11 offset:320
    ds_read_b128 v[88:91], v11 offset:384
    s_waitcnt lgkmcnt(6)
    v_smfmac_f32_16x16x64_bf16 v[32:35], v[64:67], v[128:135], v44
    s_waitcnt lgkmcnt(5)
    v_smfmac_f32_16x16x64_bf16 v[32:35], v[68:71], v[136:143], v44
    s_waitcnt lgkmcnt(4)
    v_smfmac_f32_16x16x64_bf16 v[32:35], v[72:75], v[144:151], v44
    s_waitcnt lgkmcnt(3)
    v_smfmac_f32_16x16x64_bf16 v[32:35], v[76:79], v[152:159], v44
    s_waitcnt lgkmcnt(2)
    v_smfmac_f32_16x16x64_bf16 v[32:35], v[80:83], v[160:167], v44
    s_waitcnt lgkmcnt(1)
    v_smfmac_f32_16x16x64_bf16 v[32:35], v[84:87], v[168:175], v44
    s_waitcnt lgkmcnt(0)
    v_smfmac_f32_16x16x64_bf16 v[32:35], v[88:91], v[176:183], v44
    s_cmp_eq_u32 s28, 7
    s_nop 6
    v_add_f32 v20, v32, v33
    v_cvt_pk_bf16_f32 v20, v20, v20
    v_lshlrev_b32 v20, 16, v20
    v_mul_f32 v21, 0xbfb8aa3b, v20
    v_exp_f32 v21, v21
    v_mov_b32_dpp v22, v20 row_ror:8 row_mask:0xf bank_mask:0xf
    v_add_f32 v21, 1.0, v21
    v_rcp_f32 v21, v21
    s_mov_b32 exec_lo, 0x00ff00ff
    v_mul_f32 v20, v20, v21
    v_cvt_pk_bf16_f32 v20, v20, v20
    v_lshlrev_b32 v20, 16, v20
    s_mov_b32 exec_hi, 0
    v_mul_f32 v20, v20, v22
    v_cvt_pk_bf16_f32 v20, v20, v20
    ds_write_b16 v13, v20
    s_mov_b64 exec, -1
    s_waitcnt lgkmcnt(0)
    s_barrier
    s_cbranch_scc1 Lfin
    ds_read_b128 v[64:67], v52
    ds_read_b128 v[68:71], v53
    ds_read_b128 v[72:75], v54
    ds_read_b128 v[76:79], v55
    s_waitcnt lgkmcnt(3)
    v_smfmac_f32_16x16x64_bf16 v[36:39], v[64:67], v[192:199], v44
    s_waitcnt lgkmcnt(2)
    v_smfmac_f32_16x16x64_bf16 v[36:39], v[68:71], v[200:207], v44
    s_waitcnt lgkmcnt(1)
    v_smfmac_f32_16x16x64_bf16 v[36:39], v[72:75], v[208:215], v44
    s_waitcnt lgkmcnt(0)
    v_smfmac_f32_16x16x64_bf16 v[36:39], v[76:79], v[216:223], v44
    s_nop 7
    v_add_f32 v48, v36, v37
    buffer_store_dwordx2 v[48:49], v15, s[16:19], s42 offen sc1
    v_add_f32 v50, v38, v39
    buffer_store_dwordx2 v[50:51], v15, s[16:19], s43 offen sc1
Lfend:
    s_endpgm
Lfnew:
    s_mov_b64 exec, -1
    v_min_u32_dpp v58, v56, v56 row_ror:1 row_mask:0xf bank_mask:0xf
    v_max_u32_dpp v56, v56, v56 row_ror:1 row_mask:0xf bank_mask:0xf
    v_max_u32_dpp v57, v57, v57 row_ror:1 row_mask:0xf bank_mask:0xf
    v_max_u32 v57, v57, v58
    v_min_u32_dpp v58, v56, v56 row_ror:2 row_mask:0xf bank_mask:0xf
    v_max_u32_dpp v56, v56, v56 row_ror:2 row_mask:0xf bank_mask:0xf
    v_max_u32_dpp v57, v57, v57 row_ror:2 row_mask:0xf bank_mask:0xf
    v_max_u32 v57, v57, v58
    v_min_u32_dpp v58, v56, v56 row_ror:4 row_mask:0xf bank_mask:0xf
    v_max_u32_dpp v56, v56, v56 row_ror:4 row_mask:0xf bank_mask:0xf
    v_max_u32_dpp v57, v57, v57 row_ror:4 row_mask:0xf bank_mask:0xf
    v_max_u32 v57, v57, v58
    v_min_u32_dpp v58, v56, v56 row_ror:8 row_mask:0xf bank_mask:0xf
    v_max_u32_dpp v56, v56, v56 row_ror:8 row_mask:0xf bank_mask:0xf
    v_max_u32_dpp v57, v57, v57 row_ror:8 row_mask:0xf bank_mask:0xf
    v_max_u32 v57, v57, v58
    v_readlane_b32 s59, v56, 0
    v_readlane_b32 s35, v56, 16
    v_readlane_b32 s60, v57, 0
    v_readlane_b32 s36, v57, 16
    s_min_u32 s37, s59, s35
    s_max_u32 s59, s59, s35
    s_max_u32 s60, s60, s36
    s_max_u32 s60, s60, s37
    s_bfe_u32 s38, s59, 0x50006
    s_bfe_u32 s39, s60, 0x50006
    s_cmp_eq_u32 s38, s39
    s_cselect_b32 s35, 4096, 0
    s_lshl_b32 s38, s38, 13
    s_add_u32 s38, s38, 262144
    s_lshl_b32 s39, s39, 13
    s_add_u32 s39, s39, s35
    s_add_u32 s39, s39, 262144
    s_cmp_ge_u32 s55, 14
    s_cselect_b32 s46, s39, s38
    s_cselect_b32 s40, s60, s59
Lfc:
    buffer_load_dwordx3 v[16:18], v5, s[16:19], s38 offen sc1
    buffer_load_dwordx3 v[20:22], v5, s[16:19], s38 offen offset:896 sc1
    buffer_load_dwordx3 v[24:26], v5, s[16:19], s39 offen sc1
    buffer_load_dwordx3 v[28:30], v5, s[16:19], s39 offen offset:896 sc1
    buffer_load_dwordx4 v[40:43], v9, s[16:19], s46 offen offset:2048 sc1
    s_max_u32 exec_lo, s48, 1
    s_mov_b32 exec_hi, 0
    buffer_load_dwordx3 v[60:62], v3, s[16:19], s47 offen sc1
    s_mov_b64 exec, -1
    s_sub_u32 s58, s58, 1
    s_bitcmp1_b32 s58, 31
    s_cbranch_scc1 Lf2
    s_waitcnt vmcnt(2)
    v_xor_b32 v18, s33, v18
    v_xor_b32 v22, s33, v22
    v_xor_b32 v26, s33, v26
    v_xor_b32 v30, s33, v30
    v_or3_b32 v18, v18, v22, v26
    v_or_b32 v18, v18, v30
    v_cmp_ne_u32 vcc, 0, v18
    s_cbranch_vccnz Lfc
    ds_write2_b32 v4, v16, v17 offset1:112
    ds_write2_b32 v4, v20, v21 offset0:56 offset1:168
    ds_write2_b32 v12, v24, v25 offset1:112
    ds_write2_b32 v12, v28, v29 offset0:56 offset1:168
Lstop28:
    s_cbranch_execz Ltour_ret
    s_cmp_eq_u32 s48, 0
    s_cbranch_scc1 Lf2
    s_mov_b64 exec, s[48:49]
    s_branch Lfs0
Lfh:
    buffer_load_dwordx4 v[40:43], v9, s[16:19], s46 offen offset:2048 sc1
    s_sub_u32 s58, s58, 1
    s_bitcmp1_b32 s58, 31
    s_cbranch_scc1 Lfhx
Lfin:
    ds_read_b32 v20, v14
    s_waitcnt vmcnt(0)
    v_cmp_ne_u32 vcc, s33, v42
    s_cbranch_vccnz Lfh
Lfhx:
    s_and_b32 s40, s40, 0x7ff
    s_mul_i32 s40, s40, 896
    s_add_u32 s40, s40, s43
    s_waitcnt vmcnt(0) lgkmcnt(0)
    v_cndmask_b32 v16, v40, v41, s[44:45]
    v_cvt_pk_bf16_f32 v19, v43, v43
    v_lshlrev_b32 v19, 16, v19
    v_mul_f32 v19, 0xbfb8aa3b, v19
    v_exp_f32 v19, v19
    v_lshlrev_b32 v22, 16, v20
    v_add_f32 v19, 1.0, v19
    v_rcp_f32 v19, v19
    v_and_b32 v23, 0xffff0000, v20
    v_cvt_pk_bf16_f32 v18, v19, v19
    v_and_b32 v17, 0xffff0000, v16
    v_lshlrev_b32 v16, 16, v16
    v_lshlrev_b32 v18, 16, v18
    s_barrier
Lfp:
    buffer_load_dwordx4 v[64:67], v7, s[16:19], s41 offen offset:0 sc1
    buffer_load_dwordx4 v[68:71], v7, s[16:19], s41 offen offset:1024 sc1
    buffer_load_dwordx4 v[72:75], v7, s[16:19], s41 offen offset:2048 sc1
    buffer_load_dwordx4 v[76:79], v7, s[16:19], s41 offen offset:3072 sc1
    buffer_load_dwordx4 v[80:83], v7, s[16:19], s42 offen offset:0 sc1
    buffer_load_dwordx4 v[84:87], v7, s[16:19], s42 offen offset:1024 sc1
    buffer_load_dwordx4 v[88:91], v7, s[16:19], s42 offen offset:2048 sc1
    s_sub_u32 s58, s58, 1
    s_bitcmp1_b32 s58, 31
    s_cbranch_scc1 Lfpx
    s_waitcnt vmcnt(6)
    v_and_b32 v24, v65, v67
    v_or_b32 v25, v65, v67
    s_waitcnt vmcnt(5)
    v_bitop3_b32 v24, v24, v69, v71 bitop3:0x80
    v_or3_b32 v25, v25, v69, v71
    v_add_f32 v64, v64, v68
    v_add_f32 v66, v66, v70
    s_waitcnt vmcnt(4)
    v_bitop3_b32 v24, v24, v73, v75 bitop3:0x80
    v_or3_b32 v25, v25, v73, v75
    v_add_f32 v64, v64, v72
    v_add_f32 v66, v66, v74
    s_waitcnt vmcnt(3)
    v_bitop3_b32 v24, v24, v77, v79 bitop3:0x80
    v_or3_b32 v25, v25, v77, v79
    v_add_f32 v64, v64, v76
    v_add_f32 v66, v66, v78
    s_waitcnt vmcnt(2)
    v_bitop3_b32 v24, v24, v81, v83 bitop3:0x80
    v_or3_b32 v25, v25, v81, v83
    v_add_f32 v64, v64, v80
    v_add_f32 v66, v66, v82
    s_waitcnt vmcnt(1)
    v_bitop3_b32 v24, v24, v85, v87 bitop3:0x80
    v_or3_b32 v25, v25, v85, v87
    v_add_f32 v64, v64, v84
    v_add_f32 v66, v66, v86
    s_waitcnt vmcnt(0)
    v_bitop3_b32 v24, v24, v89, v91 bitop3:0x80
    v_or3_b32 v25, v25, v89, v91
    v_add_f32 v64, v64, v88
    v_add_f32 v66, v66, v90
    v_cmp_ne_u32 vcc, s33, v24
    v_cmp_ne_u32 s[46:47], s33, v25
    v_mov_b32 v65, v64
    v_mov_b32 v67, v66
    s_or_b64 vcc, vcc, s[46:47]
    s_cbranch_scc1 Lfp
Lfpx:
    s_waitcnt vmcnt(0)
    v_permlane32_swap_b32 v65, v64
    v_permlane32_swap_b32 v67, v66
    v_add_f32 v64, v64, v65
    v_add_f32 v66, v66, v67
    v_mov_b32 v65, v64
    v_mov_b32 v67, v66
    s_nop 0
    v_permlane16_swap_b32 v65, v64
    v_permlane16_swap_b32 v67, v66
    v_add_f32 v64, v64, v65
    v_add_f32 v66, v66, v67
    v_cvt_pk_bf16_f32 v65, v64, v66
    v_lshlrev_b32 v64, 16, v65
    v_and_b32 v65, 0xffff0000, v65
    v_mul_f32 v64, v64, v18
    v_mul_f32 v65, v65, v18
    v_cvt_pk_bf16_f32 v65, v64, v65
    v_lshlrev_b32 v64, 16, v65
    v_and_b32 v65, 0xffff0000, v65
    v_add_f32 v64, v64, v22
    v_add_f32 v65, v65, v23
    v_cvt_pk_bf16_f32 v65, v64, v65
    v_lshlrev_b32 v64, 16, v65
    v_and_b32 v65, 0xffff0000, v65
    v_add_f32 v64, v64, v16
    v_add_f32 v65, v65, v17
    v_cvt_pk_bf16_f32 v64, v64, v65
    s_mov_b64 exec, 0xffff
    buffer_store_dword v64, v10, s[24:27], s40 offen
    s_mov_b64 exec, -1
    s_endpgm
Lidle:
    s_lshl_b32 s35, s55, 3
    s_add_u32 s35, s35, s28
    s_cmp_eq_u32 s35, 224
    s_cbranch_scc0 Lfend
    v_and_b32 v3, 31, v2
    v_lshlrev_b32 v3, 7, v3
    s_movk_i32 s38, 4096
Lan:
    buffer_load_dwordx3 v[24:26], v3, s[16:19], s38 offen sc1
    s_sub_u32 s58, s58, 1
    s_bitcmp1_b32 s58, 31
    s_cbranch_scc1 Lanx
    s_waitcnt vmcnt(0)
    v_cmp_ne_u32 vcc, s33, v26
    s_cbranch_vccnz Lan
Lanx:
    s_waitcnt vmcnt(0)
    v_min_u32_dpp v26, v24, v24 row_ror:1 row_mask:0xf bank_mask:0xf
    v_max_u32_dpp v24, v24, v24 row_ror:1 row_mask:0xf bank_mask:0xf
    v_max_u32_dpp v25, v25, v25 row_ror:1 row_mask:0xf bank_mask:0xf
    v_max_u32 v25, v25, v26
    v_min_u32_dpp v26, v24, v24 row_ror:2 row_mask:0xf bank_mask:0xf
    v_max_u32_dpp v24, v24, v24 row_ror:2 row_mask:0xf bank_mask:0xf
    v_max_u32_dpp v25, v25, v25 row_ror:2 row_mask:0xf bank_mask:0xf
    v_max_u32 v25, v25, v26
    v_min_u32_dpp v26, v24, v24 row_ror:4 row_mask:0xf bank_mask:0xf
    v_max_u32_dpp v24, v24, v24 row_ror:4 row_mask:0xf bank_mask:0xf
    v_max_u32_dpp v25, v25, v25 row_ror:4 row_mask:0xf bank_mask:0xf
    v_max_u32 v25, v25, v26
    v_min_u32_dpp v26, v24, v24 row_ror:8 row_mask:0xf bank_mask:0xf
    v_max_u32_dpp v24, v24, v24 row_ror:8 row_mask:0xf bank_mask:0xf
    v_max_u32_dpp v25, v25, v25 row_ror:8 row_mask:0xf bank_mask:0xf
    v_max_u32 v25, v25, v26
    v_readlane_b32 s59, v24, 0
    v_readlane_b32 s35, v24, 16
    v_readlane_b32 s60, v25, 0
    v_readlane_b32 s36, v25, 16
    s_min_u32 s37, s59, s35
    s_max_u32 s59, s59, s35
    s_max_u32 s60, s60, s36
    s_max_u32 s60, s60, s37
    v_mov_b32 v32, s59
    v_mov_b32 v33, s60
    v_mov_b32 v34, s33
    s_mov_b64 exec, 1
    buffer_store_dwordx3 v[32:34], v120, s[16:19], 0 offen offset:2048 sc1
    buffer_store_dword v34, v120, s[16:19], 0 offen
    s_mov_b64 exec, -1
    s_branch Lfend
Lre:
Lstop29:
    s_cbranch_execz Ltour_ret
    v_bfrev_b32 v5, 2
    v_cmp_le_i32 s[64:65], 0, v35
    v_cmp_le_i32 s[66:67], 0, v39
    v_cmp_le_i32 s[68:69], 0, v43
    v_cmp_le_i32 s[70:71], 0, v47
    v_cmp_le_i32 s[72:73], 0, v51
    v_cmp_le_i32 s[74:75], 0, v55
    v_cmp_le_i32 s[76:77], 0, v59
    v_cmp_le_i32 s[78:79], 0, v63
Lre1:
    s_or_b64 s[36:37], s[64:65], s[66:67]
    s_cbranch_scc0 Lre2_0
    v_cndmask_b32 v3, v5, v124, s[64:65]
    s_add_u32 s35, s6, 0
    buffer_load_dwordx4 v[32:35], v3, s[16:19], s35 offen sc1
    v_cndmask_b32 v4, v5, v124, s[66:67]
    s_add_u32 s35, s6, 131072
    buffer_load_dwordx4 v[36:39], v4, s[16:19], s35 offen sc1
Lre2_0:
    s_or_b64 s[36:37], s[68:69], s[70:71]
    s_cbranch_scc0 Lre2_1
    v_cndmask_b32 v3, v5, v124, s[68:69]
    s_add_u32 s35, s6, 262144
    buffer_load_dwordx4 v[40:43], v3, s[16:19], s35 offen sc1
    v_cndmask_b32 v4, v5, v124, s[70:71]
    s_add_u32 s35, s6, 393216
    buffer_load_dwordx4 v[44:47], v4, s[16:19], s35 offen sc1
Lre2_1:
    s_or_b64 s[36:37], s[72:73], s[74:75]
    s_cbranch_scc0 Lre2_2
    v_cndmask_b32 v3, v5, v124, s[72:73]
    s_add_u32 s35, s34, 524288
    buffer_load_dwordx4 v[48:51], v3, s[16:19], s35 offen sc1
    v_cndmask_b32 v4, v5, v124, s[74:75]
    s_add_u32 s35, s34, 655360
    buffer_load_dwordx4 v[52:55], v4, s[16:19], s35 offen sc1
Lre2_2:
    s_or_b64 s[36:37], s[76:77], s[78:79]
    s_cbranch_scc0 Lre2_3
    v_cndmask_b32 v3, v5, v124, s[76:77]
    s_add_u32 s35, s34, 786432
    buffer_load_dwordx4 v[56:59], v3, s[16:19], s35 offen sc1
    v_cndmask_b32 v4, v5, v124, s[78:79]
    s_add_u32 s35, s34, 917504
    buffer_load_dwordx4 v[60:63], v4, s[16:19], s35 offen sc1
Lre2_3:
    s_mov_b64 s[46:47], 0
    s_sub_u32 s58, s58, 1
    s_waitcnt vmcnt(0)
    s_or_b64 s[36:37], s[64:65], s[66:67]
    s_cbranch_scc0 Lre3_0
    v_cmp_le_i32 vcc, 0, v35
    v_cmp_le_i32 s[36:37], 0, v39
    v_mfma_f32_16x16x32_bf16 v[16:19], v[128:131], v[32:35], v[16:19]
    v_mfma_f32_16x16x32_bf16 v[20:23], v[132:135], v[32:35], v[20:23]
    v_mfma_f32_16x16x32_bf16 v[24:27], v[136:139], v[32:35], v[24:27]
    v_mfma_f32_16x16x32_bf16 v[28:31], v[140:143], v[32:35], v[28:31]
    v_mfma_f32_16x16x32_bf16 v[16:19], v[144:147], v[36:39], v[16:19]
    v_mfma_f32_16x16x32_bf16 v[20:23], v[148:151], v[36:39], v[20:23]
    v_mfma_f32_16x16x32_bf16 v[24:27], v[152:155], v[36:39], v[24:27]
    v_mfma_f32_16x16x32_bf16 v[28:31], v[156:159], v[36:39], v[28:31]
    s_and_b64 s[64:65], s[64:65], vcc
    s_and_b64 s[66:67], s[66:67], s[36:37]
    s_or_b64 s[46:47], s[46:47], s[64:65]
    s_or_b64 s[46:47], s[46:47], s[66:67]
Lre3_0:
    s_or_b64 s[36:37], s[68:69], s[70:71]
    s_cbranch_scc0 Lre3_1
    v_cmp_le_i32 vcc, 0, v43
    v_cmp_le_i32 s[36:37], 0, v47
    v_mfma_f32_16x16x32_bf16 v[16:19], v[160:163], v[40:43], v[16:19]
    v_mfma_f32_16x16x32_bf16 v[20:23], v[164:167], v[40:43], v[20:23]
    v_mfma_f32_16x16x32_bf16 v[24:27], v[168:171], v[40:43], v[24:27]
    v_mfma_f32_16x16x32_bf16 v[28:31], v[172:175], v[40:43], v[28:31]
    v_mfma_f32_16x16x32_bf16 v[16:19], v[176:179], v[44:47], v[16:19]
    v_mfma_f32_16x16x32_bf16 v[20:23], v[180:183], v[44:47], v[20:23]
    v_mfma_f32_16x16x32_bf16 v[24:27], v[184:187], v[44:47], v[24:27]
    v_mfma_f32_16x16x32_bf16 v[28:31], v[188:191], v[44:47], v[28:31]
    s_and_b64 s[68:69], s[68:69], vcc
    s_and_b64 s[70:71], s[70:71], s[36:37]
    s_or_b64 s[46:47], s[46:47], s[68:69]
    s_or_b64 s[46:47], s[46:47], s[70:71]
Lre3_1:
    s_or_b64 s[36:37], s[72:73], s[74:75]
    s_cbranch_scc0 Lre3_2
    v_cmp_le_i32 vcc, 0, v51
    v_cmp_le_i32 s[36:37], 0, v55
    v_mfma_f32_16x16x32_bf16 v[16:19], v[192:195], v[48:51], v[16:19]
    v_mfma_f32_16x16x32_bf16 v[20:23], v[196:199], v[48:51], v[20:23]
    v_mfma_f32_16x16x32_bf16 v[24:27], v[200:203], v[48:51], v[24:27]
    v_mfma_f32_16x16x32_bf16 v[28:31], v[204:207], v[48:51], v[28:31]
    v_mfma_f32_16x16x32_bf16 v[16:19], v[208:211], v[52:55], v[16:19]
    v_mfma_f32_16x16x32_bf16 v[20:23], v[212:215], v[52:55], v[20:23]
    v_mfma_f32_16x16x32_bf16 v[24:27], v[216:219], v[52:55], v[24:27]
    v_mfma_f32_16x16x32_bf16 v[28:31], v[220:223], v[52:55], v[28:31]
    s_and_b64 s[72:73], s[72:73], vcc
    s_and_b64 s[74:75], s[74:75], s[36:37]
    s_or_b64 s[46:47], s[46:47], s[72:73]
    s_or_b64 s[46:47], s[46:47], s[74:75]
Lre3_2:
    s_or_b64 s[36:37], s[76:77], s[78:79]
    s_cbranch_scc0 Lre3_3
    v_cmp_le_i32 vcc, 0, v59
    v_cmp_le_i32 s[36:37], 0, v63
    v_mfma_f32_16x16x32_bf16 v[16:19], v[224:227], v[56:59], v[16:19]
    v_mfma_f32_16x16x32_bf16 v[20:23], v[228:231], v[56:59], v[20:23]
    v_mfma_f32_16x16x32_bf16 v[24:27], v[232:235], v[56:59], v[24:27]
    v_mfma_f32_16x16x32_bf16 v[28:31], v[236:239], v[56:59], v[28:31]
    v_mfma_f32_16x16x32_bf16 v[16:19], v[240:243], v[60:63], v[16:19]
    v_mfma_f32_16x16x32_bf16 v[20:23], v[244:247], v[60:63], v[20:23]
    v_mfma_f32_16x16x32_bf16 v[24:27], v[248:251], v[60:63], v[24:27]
    v_mfma_f32_16x16x32_bf16 v[28:31], v[252:255], v[60:63], v[28:31]
    s_and_b64 s[76:77], s[76:77], vcc
    s_and_b64 s[78:79], s[78:79], s[36:37]
    s_or_b64 s[46:47], s[46:47], s[76:77]
    s_or_b64 s[46:47], s[46:47], s[78:79]
Lre3_3:
    s_cmp_eq_u64 s[46:47], 0
    s_cbranch_scc1 Lrex
    s_bitcmp1_b32 s58, 31
    s_cbranch_scc0 Lre1
    s_branch Lrex
Lq1:
    ds_read_b32 v19, v21 offset:4
    s_waitcnt lgkmcnt(0)
    v_cmp_gt_u32 vcc, 4, v19
    s_cbranch_vccnz Lq1
    s_branch Lq1x
Lq2:
    ds_read_b32 v19, v21 offset:8
    s_waitcnt lgkmcnt(0)
    v_cmp_gt_u32 vcc, 8, v19
    s_cbranch_vccnz Lq2
    s_branch Lq2x
Lglob_10:
    buffer_store_dword v4, v120, s[16:19], s61 offen offset:128 sc1
    s_branch Ljoin_11
Lm1:
    v_lshrrev_b32 v14, 2, v7
    buffer_load_dword v15, v14, s[16:19], s38 offen sc1
Lstop30:
    s_cbranch_execz Ltour_ret
    s_sub_u32 s58, s58, 1
    s_bitcmp1_b32 s58, 31
    s_cbranch_scc1 Lm1x
    s_waitcnt vmcnt(0)
    v_cmp_ne_u32 vcc, s33, v15
    s_and_b32 s35, vcc_lo, vcc_hi
    s_lshr_b32 s36, s35, 16
    s_or_b32 s35, s35, s36
    s_lshl_b32 s36, s30, 3
    s_lshr_b32 s35, s35, s36
    s_and_b32 s62, s35, 3
    s_cbranch_scc1 Lm1
    s_branch Lm1x
Lfl:
    buffer_load_dword v15, v14, s[16:19], s38 offen sc1
    s_sub_u32 s58, s58, 1
    s_bitcmp1_b32 s58, 31
    s_cbranch_scc1 Lflx
    s_waitcnt vmcnt(0)
    v_cmp_ne_u32 vcc, s33, v15
    s_and_b32 s35, vcc_lo, vcc_hi
    s_cbranch_scc1 Lfl
    s_branch Lflx
Lbad:
    ds_write_b32 v6, v4
    s_branch Lbadx
Lclr0:
    buffer_load_dword v116, v115, s[16:19], s5 offen sc1
    s_sub_u32 s58, s58, 1
    s_bitcmp1_b32 s58, 31
    s_cbranch_scc1 Lclr_ok0
    s_waitcnt vmcnt(0)
    v_cmp_ne_u32 vcc, s33, v116
    s_cbranch_vccnz Lclr0
    s_branch Lclr_ok0
Lclr1:
    buffer_load_dword v116, v115, s[16:19], s5 offen sc1
    s_sub_u32 s58, s58, 1
    s_bitcmp1_b32 s58, 31
    s_cbranch_scc1 Lclr_ok1
    s_waitcnt vmcnt(0)
    v_cmp_ne_u32 vcc, s33, v116
    s_cbranch_vccnz Lclr1
    s_branch Lclr_ok1
Lglob_12:
    buffer_store_dwordx4 v[76:79], v7, s[16:19], s45 offen sc1
    s_branch Ljoin_13
Lcoldcode:
Lfallback:
    s_mov_b32 s56, -1
    s_barrier
    s_lshl_b32 s35, s32, 15
    s_add_u32 s35, s35, 1048576
    s_mov_b32 s36, 64
    v_mov_b32 v3, 0xff800000
    s_mov_b32 exec_lo, 0
    v_mov_b32 v78, 0
    s_mov_b32 exec_lo, -1
Lfb1:
    buffer_load_dwordx4 v[80:83], v7, s[16:19], s35 offen sc1
    buffer_load_dwordx4 v[84:87], v7, s[16:19], s35 offen offset:1024 sc1
    s_waitcnt vmcnt(0)
    v_mfma_f32_32x32x16_bf16 v[16:31], v[80:83], v[72:75], 0
    v_mfma_f32_32x32x16_bf16 v[16:31], v[84:87], v[76:79], v[16:31]
    s_sub_u32 s36, s36, 1
    s_and_b32 s37, s36, 7
    s_cselect_b32 s37, 0, 491520
    s_add_u32 s35, s35, s37
    s_add_u32 s35, s35, 4096
    s_nop 6
    v_max3_f32 v3, v16, v17, v3
    v_max3_f32 v3, v18, v19, v3
    v_max3_f32 v3, v20, v21, v3
    v_max3_f32 v3, v22, v23, v3
    v_max3_f32 v3, v24, v25, v3
    v_max3_f32 v3, v26, v27, v3
    v_max3_f32 v3, v28, v29, v3
    v_max3_f32 v3, v30, v31, v3
    s_cmp_lg_u32 s36, 0
    s_cbranch_scc1 Lfb1
    v_mov_b32 v5, v3
    s_nop 1
    v_permlane32_swap_b32 v5, v3
    v_max_f32 v3, v3, v5
    v_sub_f32 v3, 0, v3
    v_and_b32 v5, 0xffff0000, v3
    v_sub_f32 v3, v3, v5
    v_and_b32 v6, 0xffff0000, v3
    v_sub_f32 v3, v3, v6
    v_lshrrev_b32 v5, 16, v5
    s_mov_b32 exec_lo, 0
    v_or_b32 v78, v5, v6
    v_lshrrev_b32 v79, 16, v3
    s_mov_b32 exec_lo, -1
    s_lshl_b32 s35, s29, 11
    v_add_u32 v3, s35, v7
    ds_write_b128 v3, v[72:75] offset:0
    ds_write_b128 v3, v[76:79] offset:1024
    s_add_u32 s35, s29, 1
    s_and_b32 s44, s35, 3
    s_lshl_b32 s35, s44, 11
    v_add_u32 v16, s35, v7
    s_add_u32 s35, s29, 2
    s_and_b32 s45, s35, 3
    s_lshl_b32 s35, s45, 11
    v_add_u32 v17, s35, v7
    s_add_u32 s35, s29, 3
    s_and_b32 s46, s35, 3
    s_lshl_b32 s35, s46, 11
    v_add_u32 v18, s35, v7
    s_add_u32 s35, s29, 4
    s_and_b32 s47, s35, 3
    s_lshl_b32 s35, s47, 11
    v_add_u32 v19, s35, v7
    v_mfma_f32_32x32x16_bf16 v[128:143], v[120:123], v[120:123], 0
    v_mfma_f32_32x32x16_bf16 v[144:159], v[120:123], v[120:123], 0
    v_mfma_f32_32x32x16_bf16 v[160:175], v[120:123], v[120:123], 0
    v_mfma_f32_32x32x16_bf16 v[176:191], v[120:123], v[120:123], 0
    s_add_u32 s41, s39, s59
    buffer_load_dwordx4 v[192:195], v7, s[16:19], s41 offen offset:0 sc1
    buffer_load_dwordx4 v[196:199], v7, s[16:19], s41 offen offset:1024 sc1
    buffer_load_dwordx4 v[200:203], v7, s[16:19], s41 offen offset:2048 sc1
    buffer_load_dwordx4 v[204:207], v7, s[16:19], s41 offen offset:3072 sc1
    s_waitcnt lgkmcnt(0)
    s_barrier
    s_branch Lattn
Lexit:
    s_endpgm
.section .rodata,"a"
.p2align 6
.amdhsa_kernel sequential_preLN__mha_block__moe_arch_mod__prompt_kernel
  .amdhsa_next_free_vgpr 256
  .amdhsa_next_free_sgpr 102
  .amdhsa_accum_offset 256
  .amdhsa_group_segment_fixed_size 0
  .amdhsa_kernarg_size 88
  .amdhsa_user_sgpr_count 2
  .amdhsa_user_sgpr_kernarg_segment_ptr 1
  .amdhsa_system_sgpr_workgroup_id_x 1
.end_amdhsa_kernel
```
